```python
import torch

def _softmax(x, axis=-1):
    return torch.softmax(x, dim=axis)
def _gelu(x):
    return torch.nn.functional.gelu(x, approximate="tanh")
def _silu(x):
    return torch.nn.functional.silu(x)
def _sigmoid(x):
    return torch.sigmoid(x)
def _layernorm(x, axis=-1, eps=1e-5):
    m = x.mean(dim=axis, keepdim=True)
    v = x.var(dim=axis, keepdim=True, unbiased=False)
    return (x - m) / torch.sqrt(v + eps)
def _scatter_add(tgt, idx, src, axis=0):
    return tgt.clone().index_add_(axis, idx, src)
def _segment_sum(src, seg, n):
    out = torch.zeros((n,) + src.shape[1:], dtype=src.dtype)
    return out.index_add_(0, seg, src)
def _pad(x, pw):
    flat = tuple(v for pair in reversed(pw) for v in pair)
    return torch.nn.functional.pad(x, flat)

kernel_name = 'sequential_preLN__mha_block_cached__geglu_ffn__decode'

def setup_inputs():

    _w = (lambda a: (lambda t: t.to(torch.bfloat16) if t.is_floating_point() else t)(torch.as_tensor(a)))
    def _A_setup():
        B, Sq, D = 8, 1, 1024
        H, Sk, Dh = 32, 4096, 128
        return {
            "x": _w((lambda *s: torch.randn(*s, dtype=torch.bfloat16) * 0.05)(B, Sq, D)),
            "k_cache": _w((lambda *s: torch.randn(*s, dtype=torch.bfloat16) * 3.2)(B, H, Sk, Dh)),
            "v_cache": _w((lambda *s: torch.randn(*s, dtype=torch.bfloat16) * 0.4)(B, H, Sk, Dh)),
            "wq": _w((lambda *s: torch.randn(*s, dtype=torch.bfloat16) * 3.2)(D, H * Dh) * (D ** -0.5)),
            "wo": _w((lambda *s: torch.randn(*s, dtype=torch.bfloat16) * 0.4)(H * Dh, D) * ((H * Dh) ** -0.5)),
        }
    _A_in = _A_setup()

    def _B_setup():
        B, S, D, F = 8, 1, 1024, 3584
        return {
            "x": _w((lambda *s: torch.randn(*s, dtype=torch.bfloat16) * 0.05)(B, S, D)),
            "w_gate": _w((lambda *s: torch.randn(*s, dtype=torch.bfloat16) * 0.05)(D, F)),
            "w_up": _w((lambda *s: torch.randn(*s, dtype=torch.bfloat16) * 0.05)(D, F)),
            "w_down": _w((lambda *s: torch.randn(*s, dtype=torch.bfloat16) * 0.05)(F, D)),
        }
    _B_in = _B_setup()

    return {
        "A_x": _A_in["x"],
        "A_k_cache": _A_in["k_cache"],
        "A_v_cache": _A_in["v_cache"],
        "A_wq": _A_in["wq"],
        "A_wo": _A_in["wo"],
        "B_x": _B_in["x"],
        "B_w_gate": _B_in["w_gate"],
        "B_w_up": _B_in["w_up"],
        "B_w_down": _B_in["w_down"],
    }

def reference(A_x, A_k_cache, A_v_cache, A_wq, A_wo, B_x, B_w_gate, B_w_up, B_w_down):
    def _A_ref(x, k_cache, v_cache, wq, wo):
        B, Sq, D = x.shape
        H, Dh = 32, 128
        q = (lambda x, *d: x.permute(*d))((x @ wq).reshape(B, Sq, H, Dh), 0, 2, 1, 3)
        scores = torch.einsum("bhqd,bhkd->bhqk", q, k_cache) * (Dh ** -0.5)
        p = _softmax(scores, axis=-1)
        o = torch.einsum("bhqk,bhkd->bhqd", p, v_cache)
        return (lambda x, *d: x.permute(*d))(o, 0, 2, 1, 3).reshape(B, Sq, H * Dh) @ wo

    def _B_ref(x, w_gate, w_up, w_down):
        return (_gelu(x @ w_gate) * (x @ w_up)) @ w_down

    x = A_x
    h = x + _A_ref(_layernorm(x, axis=-1), A_k_cache, A_v_cache, A_wq, A_wo)
    h2 = h + _B_ref(_layernorm(h, axis=-1), B_w_gate, B_w_up, B_w_down)
    return h2
```

```asm
; @launch grid=(256,1,1) block=(512,1,1) lds=163840
.amdgcn_target "amdgcn-amd-amdhsa--gfx950"
.text
.globl sequential_preLN__mha_block_cached__geglu_ffn__decode_kernel
.p2align 8
.type sequential_preLN__mha_block_cached__geglu_ffn__decode_kernel,@function
sequential_preLN__mha_block_cached__geglu_ffn__decode_kernel:
s_cmp_ge_u32 s2, 256
s_cbranch_scc1 L_end
s_load_dwordx16 s[16:31], s[0:1], 0
s_load_dwordx8 s[32:39], s[0:1], 64
v_and_b32 v1, 63, v0
v_lshrrev_b32 v4, 6, v0
v_lshlrev_b32 v2, 4, v1
v_readfirstlane_b32 s72, v4
v_lshlrev_b32 v3, 2, v1
s_lshr_b32 s73, s2, 3
s_and_b32 s74, s2, 7
s_mov_b32 s88, 0x22222222
s_mov_b32 s89, 0x22222222
s_mov_b32 s90, 0x44444444
s_mov_b32 s91, 0x44444444
s_mov_b32 s92, 0x88888888
s_mov_b32 s93, 0x88888888
s_mov_b32 s94, 0x00ff00ff
s_mov_b32 s95, 0x00ff00ff
s_mov_b32 s64, 0x11111111
s_mov_b32 s65, 0x11111111
s_mov_b32 s66, 0x01010101
s_mov_b32 s67, 0x01010101
v_mov_b32 v204, 0
v_mov_b32 v4, 150016
v_mov_b32 v6, 0
v_mov_b32 v7, 0
ds_write_b64 v4, v[6:7]
ds_write_b64 v4, v[6:7] offset:8
v_mov_b32 v7, 5
ds_write_b64 v4, v[6:7] offset:16
s_and_b32 s75, s72, 3
s_cmp_ge_u32 s72, 4
s_cbranch_scc1 L_stream
v_lshrrev_b32 v4, 4, v1
v_and_b32 v5, 15, v1
s_lshr_b32 s76, s75, 1
s_lshl_b32 s76, s76, 2
v_or_b32 v6, s76, v4
v_lshlrev_b32 v6, 1, v6
v_xor_b32 v6, v6, v5
v_lshlrev_b32 v6, 4, v6
v_lshlrev_b32 v7, 13, v4
v_add_u32 v6, v6, v7
s_lshl_b32 s76, s74, 20
s_lshl_b32 s77, s75, 15
s_add_u32 s76, s76, s77
s_lshl_b32 s77, s73, 8
s_add_u32 s76, s76, s77
s_lshl_b32 s77, s75, 10
s_add_u32 s77, s77, 98304
s_lshl_b32 s78, s75, 12
v_mov_b32 v126, 0
s_mov_b32 s79, 2162688
s_waitcnt lgkmcnt(0)
s_mov_b32 s48, s16
s_mov_b32 s49, s17
s_mov_b32 s50, 16384
s_mov_b32 s51, 0x20000
buffer_load_dwordx4 v[8:11], v2, s[48:51], s78 offen
buffer_load_dwordx4 v[12:15], v2, s[48:51], s78 offen offset:1024
buffer_load_dwordx4 v[16:19], v2, s[48:51], s78 offen offset:2048
buffer_load_dwordx4 v[20:23], v2, s[48:51], s78 offen offset:3072
s_mov_b32 s52, s22
s_mov_b32 s53, s23
s_mov_b32 s54, 8388608
s_mov_b32 s55, 0x20000
s_mov_b32 m0, s77
s_add_u32 s77, s77, 4096
buffer_load_dwordx4 v6, s[52:55], s76 offen nt lds
s_add_u32 s76, s76, 131072
s_mov_b32 m0, s77
s_add_u32 s77, s77, 4096
buffer_load_dwordx4 v6, s[52:55], s76 offen nt lds
s_add_u32 s76, s76, 131072
s_mov_b32 m0, s77
s_add_u32 s77, s77, 4096
buffer_load_dwordx4 v6, s[52:55], s76 offen nt lds
s_add_u32 s76, s76, 131072
s_mov_b32 m0, s77
s_add_u32 s77, s77, 4096
buffer_load_dwordx4 v6, s[52:55], s76 offen nt lds
s_add_u32 s76, s76, 131072
s_mov_b32 m0, s77
s_add_u32 s77, s77, 4096
buffer_load_dwordx4 v6, s[52:55], s76 offen nt lds
s_add_u32 s76, s76, 131072
s_mov_b32 m0, s77
s_add_u32 s77, s77, 4096
buffer_load_dwordx4 v6, s[52:55], s76 offen nt lds
s_add_u32 s76, s76, 131072
s_mov_b32 m0, s77
s_add_u32 s77, s77, 4096
buffer_load_dwordx4 v6, s[52:55], s76 offen nt lds
s_add_u32 s76, s76, 131072
s_mov_b32 m0, s77
s_add_u32 s77, s77, 4096
buffer_load_dwordx4 v6, s[52:55], s76 offen nt lds
s_mov_b32 s60, s38
s_mov_b32 s61, s39
s_mov_b32 s62, 6291456
s_mov_b32 s63, 0x20000
buffer_load_dword v126, v126, s[60:63], s79 offen sc1
s_barrier
v_mov_b32 v24, -1
v_mov_b32 v25, -1
v_mov_b32 v26, -1
v_mov_b32 v27, -1
s_lshl_b32 s76, s2, 12
s_lshl_b32 s77, s75, 10
s_add_u32 s76, s76, s77
s_add_u32 s76, s76, 1048576
buffer_store_dwordx4 v[24:27], v2, s[60:63], s76 offen sc0 sc1
s_mov_b32 s100, 999
s_mov_b32 s101, 0
s_cmp_ge_u32 s73, 8
s_cbranch_scc1 L0
s_mov_b32 s86, 0
s_mov_b32 s51, 24
s_mov_b32 s84, 2048
s_mov_b32 s85, 32
s_lshr_b32 s76, s73, 1
s_lshl_b32 s76, s76, 21
s_and_b32 s77, s73, 1
s_lshl_b32 s78, s74, 1
s_add_u32 s77, s77, s78
s_lshl_b32 s77, s77, 7
s_add_u32 s76, s76, s77
s_add_u32 s56, s24, s76
s_addc_u32 s57, s25, 0
s_sub_u32 s58, 8388608, s76
s_branch L3
L0:
s_cmp_ge_u32 s73, 22
s_cbranch_scc1 L1
s_mov_b32 s86, 1
s_mov_b32 s51, 12
s_mov_b32 s84, 7168
s_mov_b32 s85, 32
s_sub_u32 s76, s73, 8
s_lshr_b32 s77, s76, 1
s_mul_i32 s78, s74, 7
s_add_u32 s77, s77, s78
s_lshl_b32 s77, s77, 7
s_bitcmp1_b32 s76, 0
s_cselect_b32 s78, s30, s28
s_cselect_b32 s79, s31, s29
s_add_u32 s56, s78, s77
s_addc_u32 s57, s79, 0
s_sub_u32 s58, 7340032, s77
s_branch L3
L1:
s_cmp_ge_u32 s73, 30
s_cbranch_scc1 L2
s_mov_b32 s86, 2
s_mov_b32 s51, 12
s_mov_b32 s84, 2048
s_mov_b32 s85, 28
s_mov_b32 s100, 14
s_mov_b32 s101, 4294049920
s_mul_i32 s77, s74, 917504
s_sub_u32 s76, s73, 22
s_lshl_b32 s76, s76, 8
s_add_u32 s76, s76, s77
s_add_u32 s56, s32, s76
s_addc_u32 s57, s33, 0
s_sub_u32 s58, 7340032, s76
s_branch L3
L2:
s_mov_b32 s86, 3
s_mov_b32 s51, 0
s_mov_b32 s84, 2048
s_mov_b32 s85, 0
s_mov_b32 s56, s32
s_mov_b32 s57, s33
s_mov_b32 s58, 0
L3:
s_mov_b32 s59, 0x20000
s_waitcnt vmcnt(10)
v_lshlrev_b32 v32, 16, v8
v_and_b32 v33, 0xffff0000, v8
v_lshlrev_b32 v34, 16, v9
v_and_b32 v35, 0xffff0000, v9
v_lshlrev_b32 v36, 16, v10
v_and_b32 v37, 0xffff0000, v10
v_lshlrev_b32 v38, 16, v11
v_and_b32 v39, 0xffff0000, v11
v_lshlrev_b32 v40, 16, v12
v_and_b32 v41, 0xffff0000, v12
v_lshlrev_b32 v42, 16, v13
v_and_b32 v43, 0xffff0000, v13
v_lshlrev_b32 v44, 16, v14
v_and_b32 v45, 0xffff0000, v14
v_lshlrev_b32 v46, 16, v15
v_and_b32 v47, 0xffff0000, v15
v_readfirstlane_b32 s80, v32
s_nop 1
v_pk_add_f32 v[48:49], v[32:33], s[80:81] op_sel_hi:[1,0] neg_lo:[0,1] neg_hi:[0,1]
v_pk_add_f32 v[50:51], v[34:35], s[80:81] op_sel_hi:[1,0] neg_lo:[0,1] neg_hi:[0,1]
v_pk_add_f32 v[52:53], v[36:37], s[80:81] op_sel_hi:[1,0] neg_lo:[0,1] neg_hi:[0,1]
v_pk_add_f32 v[54:55], v[38:39], s[80:81] op_sel_hi:[1,0] neg_lo:[0,1] neg_hi:[0,1]
v_pk_add_f32 v[56:57], v[40:41], s[80:81] op_sel_hi:[1,0] neg_lo:[0,1] neg_hi:[0,1]
v_pk_add_f32 v[58:59], v[42:43], s[80:81] op_sel_hi:[1,0] neg_lo:[0,1] neg_hi:[0,1]
v_pk_add_f32 v[60:61], v[44:45], s[80:81] op_sel_hi:[1,0] neg_lo:[0,1] neg_hi:[0,1]
v_pk_add_f32 v[62:63], v[46:47], s[80:81] op_sel_hi:[1,0] neg_lo:[0,1] neg_hi:[0,1]
v_pk_add_f32 v[64:65], v[48:49], v[50:51]
v_pk_mul_f32 v[66:67], v[48:49], v[48:49]
v_pk_fma_f32 v[66:67], v[50:51], v[50:51], v[66:67]
v_pk_add_f32 v[64:65], v[64:65], v[52:53]
v_pk_fma_f32 v[66:67], v[52:53], v[52:53], v[66:67]
v_pk_add_f32 v[64:65], v[64:65], v[54:55]
v_pk_fma_f32 v[66:67], v[54:55], v[54:55], v[66:67]
v_pk_add_f32 v[64:65], v[64:65], v[56:57]
v_pk_fma_f32 v[66:67], v[56:57], v[56:57], v[66:67]
v_pk_add_f32 v[64:65], v[64:65], v[58:59]
v_pk_fma_f32 v[66:67], v[58:59], v[58:59], v[66:67]
v_pk_add_f32 v[64:65], v[64:65], v[60:61]
v_pk_fma_f32 v[66:67], v[60:61], v[60:61], v[66:67]
v_pk_add_f32 v[64:65], v[64:65], v[62:63]
v_pk_fma_f32 v[66:67], v[62:63], v[62:63], v[66:67]
v_add_f32 v64, v64, v65
v_add_f32 v66, v66, v67
s_nop 0
v_add_f32_dpp v64, v64, v64 row_ror:8 row_mask:0xf bank_mask:0xf
v_add_f32_dpp v66, v66, v66 row_ror:8 row_mask:0xf bank_mask:0xf
s_nop 0
v_add_f32_dpp v64, v64, v64 row_ror:4 row_mask:0xf bank_mask:0xf
v_add_f32_dpp v66, v66, v66 row_ror:4 row_mask:0xf bank_mask:0xf
s_nop 0
v_add_f32_dpp v64, v64, v64 row_ror:2 row_mask:0xf bank_mask:0xf
v_add_f32_dpp v66, v66, v66 row_ror:2 row_mask:0xf bank_mask:0xf
s_nop 0
v_add_f32_dpp v64, v64, v64 row_ror:1 row_mask:0xf bank_mask:0xf
v_add_f32_dpp v66, v66, v66 row_ror:1 row_mask:0xf bank_mask:0xf
v_mov_b32 v68, v64
v_mov_b32 v69, v66
s_nop 0
v_permlane16_swap_b32 v64, v68
v_permlane16_swap_b32 v66, v69
v_add_f32 v64, v64, v68
v_add_f32 v66, v66, v69
v_mov_b32 v68, v64
v_mov_b32 v69, v66
s_nop 0
v_permlane32_swap_b32 v64, v68
v_permlane32_swap_b32 v66, v69
v_add_f32 v64, v64, v68
v_add_f32 v66, v66, v69
v_mul_f32 v64, 0x3a800000, v64
v_mul_f32 v66, 0x3a800000, v66
v_add_f32 v70, s80, v64
v_fma_f32 v72, -v64, v64, v66
v_max_f32 v72, 0, v72
v_cvt_pk_bf16_f32 v70, v70, v72
v_and_b32 v72, 0xffff0000, v70
v_lshlrev_b32 v70, 16, v70
v_add_f32 v72, 0x3727c5ac, v72
v_cvt_pk_bf16_f32 v72, v72, v72
v_lshlrev_b32 v72, 16, v72
v_sqrt_f32 v72, v72
s_nop 0
v_cvt_pk_bf16_f32 v72, v72, v72
v_lshlrev_b32 v72, 16, v72
v_rcp_f32 v72, v72
s_cmp_lt_u32 s74, 4
s_cbranch_scc1 L4
v_pk_mov_b32 v[32:33], v[40:41], v[40:41] op_sel:[0,1]
v_pk_mov_b32 v[34:35], v[42:43], v[42:43] op_sel:[0,1]
v_pk_mov_b32 v[36:37], v[44:45], v[44:45] op_sel:[0,1]
v_pk_mov_b32 v[38:39], v[46:47], v[46:47] op_sel:[0,1]
L4:
v_pk_add_f32 v[74:75], v[32:33], v[70:71] op_sel_hi:[1,0] neg_lo:[0,1] neg_hi:[0,1]
v_cvt_pk_bf16_f32 v74, v74, v75
v_and_b32 v75, 0xffff0000, v74
v_lshlrev_b32 v74, 16, v74
v_pk_mul_f32 v[74:75], v[74:75], v[72:73] op_sel_hi:[1,0]
v_cvt_pk_bf16_f32 v76, v74, v75
v_pk_add_f32 v[74:75], v[34:35], v[70:71] op_sel_hi:[1,0] neg_lo:[0,1] neg_hi:[0,1]
v_cvt_pk_bf16_f32 v74, v74, v75
v_and_b32 v75, 0xffff0000, v74
v_lshlrev_b32 v74, 16, v74
v_pk_mul_f32 v[74:75], v[74:75], v[72:73] op_sel_hi:[1,0]
v_cvt_pk_bf16_f32 v77, v74, v75
v_pk_add_f32 v[74:75], v[36:37], v[70:71] op_sel_hi:[1,0] neg_lo:[0,1] neg_hi:[0,1]
v_cvt_pk_bf16_f32 v74, v74, v75
v_and_b32 v75, 0xffff0000, v74
v_lshlrev_b32 v74, 16, v74
v_pk_mul_f32 v[74:75], v[74:75], v[72:73] op_sel_hi:[1,0]
v_cvt_pk_bf16_f32 v78, v74, v75
v_pk_add_f32 v[74:75], v[38:39], v[70:71] op_sel_hi:[1,0] neg_lo:[0,1] neg_hi:[0,1]
v_cvt_pk_bf16_f32 v74, v74, v75
v_and_b32 v75, 0xffff0000, v74
v_lshlrev_b32 v74, 16, v74
v_pk_mul_f32 v[74:75], v[74:75], v[72:73] op_sel_hi:[1,0]
v_cvt_pk_bf16_f32 v79, v74, v75
s_and_b32 s76, s74, 3
s_lshl_b32 s76, s76, 4
s_mov_b64 s[96:97], 0xffff
s_lshl_b64 s[96:97], s[96:97], s76
s_lshl_b32 s77, s75, 1
s_add_u32 s77, s77, 0
s_mul_i32 s77, s77, 272
s_add_u32 s77, s77, 147456
v_and_b32 v80, 15, v1
v_lshlrev_b32 v80, 4, v80
v_add_u32 v80, s77, v80
s_mov_b64 exec, s[96:97]
ds_write_b128 v80, v[76:79]
s_mov_b64 exec, -1
v_lshlrev_b32 v32, 16, v16
v_and_b32 v33, 0xffff0000, v16
v_lshlrev_b32 v34, 16, v17
v_and_b32 v35, 0xffff0000, v17
v_lshlrev_b32 v36, 16, v18
v_and_b32 v37, 0xffff0000, v18
v_lshlrev_b32 v38, 16, v19
v_and_b32 v39, 0xffff0000, v19
v_lshlrev_b32 v40, 16, v20
v_and_b32 v41, 0xffff0000, v20
v_lshlrev_b32 v42, 16, v21
v_and_b32 v43, 0xffff0000, v21
v_lshlrev_b32 v44, 16, v22
v_and_b32 v45, 0xffff0000, v22
v_lshlrev_b32 v46, 16, v23
v_and_b32 v47, 0xffff0000, v23
v_readfirstlane_b32 s80, v32
s_nop 1
v_pk_add_f32 v[48:49], v[32:33], s[80:81] op_sel_hi:[1,0] neg_lo:[0,1] neg_hi:[0,1]
v_pk_add_f32 v[50:51], v[34:35], s[80:81] op_sel_hi:[1,0] neg_lo:[0,1] neg_hi:[0,1]
v_pk_add_f32 v[52:53], v[36:37], s[80:81] op_sel_hi:[1,0] neg_lo:[0,1] neg_hi:[0,1]
v_pk_add_f32 v[54:55], v[38:39], s[80:81] op_sel_hi:[1,0] neg_lo:[0,1] neg_hi:[0,1]
v_pk_add_f32 v[56:57], v[40:41], s[80:81] op_sel_hi:[1,0] neg_lo:[0,1] neg_hi:[0,1]
v_pk_add_f32 v[58:59], v[42:43], s[80:81] op_sel_hi:[1,0] neg_lo:[0,1] neg_hi:[0,1]
v_pk_add_f32 v[60:61], v[44:45], s[80:81] op_sel_hi:[1,0] neg_lo:[0,1] neg_hi:[0,1]
v_pk_add_f32 v[62:63], v[46:47], s[80:81] op_sel_hi:[1,0] neg_lo:[0,1] neg_hi:[0,1]
v_pk_add_f32 v[64:65], v[48:49], v[50:51]
v_pk_mul_f32 v[66:67], v[48:49], v[48:49]
v_pk_fma_f32 v[66:67], v[50:51], v[50:51], v[66:67]
v_pk_add_f32 v[64:65], v[64:65], v[52:53]
v_pk_fma_f32 v[66:67], v[52:53], v[52:53], v[66:67]
v_pk_add_f32 v[64:65], v[64:65], v[54:55]
v_pk_fma_f32 v[66:67], v[54:55], v[54:55], v[66:67]
v_pk_add_f32 v[64:65], v[64:65], v[56:57]
v_pk_fma_f32 v[66:67], v[56:57], v[56:57], v[66:67]
v_pk_add_f32 v[64:65], v[64:65], v[58:59]
v_pk_fma_f32 v[66:67], v[58:59], v[58:59], v[66:67]
v_pk_add_f32 v[64:65], v[64:65], v[60:61]
v_pk_fma_f32 v[66:67], v[60:61], v[60:61], v[66:67]
v_pk_add_f32 v[64:65], v[64:65], v[62:63]
v_pk_fma_f32 v[66:67], v[62:63], v[62:63], v[66:67]
v_add_f32 v64, v64, v65
v_add_f32 v66, v66, v67
s_nop 0
v_add_f32_dpp v64, v64, v64 row_ror:8 row_mask:0xf bank_mask:0xf
v_add_f32_dpp v66, v66, v66 row_ror:8 row_mask:0xf bank_mask:0xf
s_nop 0
v_add_f32_dpp v64, v64, v64 row_ror:4 row_mask:0xf bank_mask:0xf
v_add_f32_dpp v66, v66, v66 row_ror:4 row_mask:0xf bank_mask:0xf
s_nop 0
v_add_f32_dpp v64, v64, v64 row_ror:2 row_mask:0xf bank_mask:0xf
v_add_f32_dpp v66, v66, v66 row_ror:2 row_mask:0xf bank_mask:0xf
s_nop 0
v_add_f32_dpp v64, v64, v64 row_ror:1 row_mask:0xf bank_mask:0xf
v_add_f32_dpp v66, v66, v66 row_ror:1 row_mask:0xf bank_mask:0xf
v_mov_b32 v68, v64
v_mov_b32 v69, v66
s_nop 0
v_permlane16_swap_b32 v64, v68
v_permlane16_swap_b32 v66, v69
v_add_f32 v64, v64, v68
v_add_f32 v66, v66, v69
v_mov_b32 v68, v64
v_mov_b32 v69, v66
s_nop 0
v_permlane32_swap_b32 v64, v68
v_permlane32_swap_b32 v66, v69
v_add_f32 v64, v64, v68
v_add_f32 v66, v66, v69
v_mul_f32 v64, 0x3a800000, v64
v_mul_f32 v66, 0x3a800000, v66
v_add_f32 v70, s80, v64
v_fma_f32 v72, -v64, v64, v66
v_max_f32 v72, 0, v72
v_cvt_pk_bf16_f32 v70, v70, v72
v_and_b32 v72, 0xffff0000, v70
v_lshlrev_b32 v70, 16, v70
v_add_f32 v72, 0x3727c5ac, v72
v_cvt_pk_bf16_f32 v72, v72, v72
v_lshlrev_b32 v72, 16, v72
v_sqrt_f32 v72, v72
s_nop 0
v_cvt_pk_bf16_f32 v72, v72, v72
v_lshlrev_b32 v72, 16, v72
v_rcp_f32 v72, v72
s_cmp_lt_u32 s74, 4
s_cbranch_scc1 L5
v_pk_mov_b32 v[32:33], v[40:41], v[40:41] op_sel:[0,1]
v_pk_mov_b32 v[34:35], v[42:43], v[42:43] op_sel:[0,1]
v_pk_mov_b32 v[36:37], v[44:45], v[44:45] op_sel:[0,1]
v_pk_mov_b32 v[38:39], v[46:47], v[46:47] op_sel:[0,1]
L5:
v_pk_add_f32 v[74:75], v[32:33], v[70:71] op_sel_hi:[1,0] neg_lo:[0,1] neg_hi:[0,1]
v_cvt_pk_bf16_f32 v74, v74, v75
v_and_b32 v75, 0xffff0000, v74
v_lshlrev_b32 v74, 16, v74
v_pk_mul_f32 v[74:75], v[74:75], v[72:73] op_sel_hi:[1,0]
v_cvt_pk_bf16_f32 v76, v74, v75
v_pk_add_f32 v[74:75], v[34:35], v[70:71] op_sel_hi:[1,0] neg_lo:[0,1] neg_hi:[0,1]
v_cvt_pk_bf16_f32 v74, v74, v75
v_and_b32 v75, 0xffff0000, v74
v_lshlrev_b32 v74, 16, v74
v_pk_mul_f32 v[74:75], v[74:75], v[72:73] op_sel_hi:[1,0]
v_cvt_pk_bf16_f32 v77, v74, v75
v_pk_add_f32 v[74:75], v[36:37], v[70:71] op_sel_hi:[1,0] neg_lo:[0,1] neg_hi:[0,1]
v_cvt_pk_bf16_f32 v74, v74, v75
v_and_b32 v75, 0xffff0000, v74
v_lshlrev_b32 v74, 16, v74
v_pk_mul_f32 v[74:75], v[74:75], v[72:73] op_sel_hi:[1,0]
v_cvt_pk_bf16_f32 v78, v74, v75
v_pk_add_f32 v[74:75], v[38:39], v[70:71] op_sel_hi:[1,0] neg_lo:[0,1] neg_hi:[0,1]
v_cvt_pk_bf16_f32 v74, v74, v75
v_and_b32 v75, 0xffff0000, v74
v_lshlrev_b32 v74, 16, v74
v_pk_mul_f32 v[74:75], v[74:75], v[72:73] op_sel_hi:[1,0]
v_cvt_pk_bf16_f32 v79, v74, v75
s_and_b32 s76, s74, 3
s_lshl_b32 s76, s76, 4
s_mov_b64 s[96:97], 0xffff
s_lshl_b64 s[96:97], s[96:97], s76
s_lshl_b32 s77, s75, 1
s_add_u32 s77, s77, 1
s_mul_i32 s77, s77, 272
s_add_u32 s77, s77, 147456
v_and_b32 v80, 15, v1
v_lshlrev_b32 v80, 4, v80
v_add_u32 v80, s77, v80
s_mov_b64 exec, s[96:97]
ds_write_b128 v80, v[76:79]
s_mov_b64 exec, -1
v_and_b32 v58, 7, v1
v_mul_u32_u24 v58, 272, v58
v_lshrrev_b32 v59, 4, v1
v_lshlrev_b32 v60, 4, v59
v_add_u32 v58, v58, v60
v_add_u32 v58, 147456, v58
v_and_b32 v60, 15, v1
v_lshrrev_b32 v61, 2, v60
v_and_b32 v62, 3, v60
v_and_b32 v63, 1, v59
v_lshlrev_b32 v63, 2, v63
v_or_b32 v63, v63, v61
v_lshlrev_b32 v80, 3, v59
v_add_u32 v80, v80, v61
v_lshlrev_b32 v80, 8, v80
v_lshlrev_b32 v62, 3, v62
v_add_u32 v80, v80, v62
v_add_u32 v80, 98304, v80
s_lshl_b32 s76, s75, 1
v_xor_b32 v81, s76, v63
v_lshlrev_b32 v81, 5, v81
v_add_u32 v81, v81, v80
s_add_u32 s76, s76, 1
v_xor_b32 v82, s76, v63
v_lshlrev_b32 v82, 5, v82
v_add_u32 v82, v82, v80
v_and_b32 v56, 15, v1
v_lshlrev_b32 v56, 12, v56
v_lshlrev_b32 v60, 4, v59
v_add_u32 v56, v56, v60
s_waitcnt vmcnt(2) lgkmcnt(0)
s_mov_b64 exec, 1
v_mov_b32 v124, 150016
v_mov_b32 v125, 1
ds_add_u32 v124, v125
s_mov_b64 exec, -1
v_mov_b32 v124, 150016
s_mov_b32 s83, 0
L6:
ds_read_b32 v125, v124
s_waitcnt lgkmcnt(0)
v_readfirstlane_b32 s81, v125
s_nop 0
s_cmp_ge_u32 s81, 4
s_cbranch_scc1 L7
s_add_u32 s83, s83, 1
s_cmp_gt_u32 s83, 4194304
s_cbranch_scc1 L7
s_branch L6
L7:
ds_read_b128 v[64:67], v58 offset:0
ds_read_b128 v[68:71], v58 offset:64
ds_read_b128 v[72:75], v58 offset:128
ds_read_b128 v[76:79], v58 offset:192
ds_read_b64_tr_b16 v[84:85], v81 offset:0
ds_read_b64_tr_b16 v[86:87], v81 offset:1024
ds_read_b64_tr_b16 v[88:89], v81 offset:8192
ds_read_b64_tr_b16 v[90:91], v81 offset:9216
ds_read_b64_tr_b16 v[92:93], v81 offset:16384
ds_read_b64_tr_b16 v[94:95], v81 offset:17408
ds_read_b64_tr_b16 v[96:97], v81 offset:24576
ds_read_b64_tr_b16 v[98:99], v81 offset:25600
ds_read_b64_tr_b16 v[100:101], v82 offset:0
ds_read_b64_tr_b16 v[102:103], v82 offset:1024
ds_read_b64_tr_b16 v[104:105], v82 offset:8192
ds_read_b64_tr_b16 v[106:107], v82 offset:9216
ds_read_b64_tr_b16 v[108:109], v82 offset:16384
ds_read_b64_tr_b16 v[110:111], v82 offset:17408
ds_read_b64_tr_b16 v[112:113], v82 offset:24576
ds_read_b64_tr_b16 v[114:115], v82 offset:25600
s_lshl_b32 s76, s73, 15
s_lshl_b32 s77, s74, 9
s_add_u32 s76, s76, s77
s_lshl_b32 s77, s75, 7
s_add_u32 s76, s76, s77
s_waitcnt lgkmcnt(0)
v_mfma_f32_16x16x32_bf16 v[116:119], v[84:87], v[64:67], 0
v_mfma_f32_16x16x32_bf16 v[120:123], v[100:103], v[64:67], 0
v_mfma_f32_16x16x32_bf16 v[116:119], v[88:91], v[68:71], v[116:119]
v_mfma_f32_16x16x32_bf16 v[120:123], v[104:107], v[68:71], v[120:123]
v_mfma_f32_16x16x32_bf16 v[116:119], v[92:95], v[72:75], v[116:119]
v_mfma_f32_16x16x32_bf16 v[120:123], v[108:111], v[72:75], v[120:123]
v_mfma_f32_16x16x32_bf16 v[116:119], v[96:99], v[76:79], v[116:119]
v_mfma_f32_16x16x32_bf16 v[120:123], v[112:115], v[76:79], v[120:123]
s_mov_b64 exec, 1
v_mov_b32 v124, 150020
v_mov_b32 v125, 1
ds_add_u32 v124, v125
s_mov_b64 exec, -1
s_mov_b64 exec, s[94:95]
s_nop 0
buffer_store_dwordx4 v[116:119], v56, s[60:63], s76 offen sc0 sc1
buffer_store_dwordx4 v[120:123], v56, s[60:63], s76 offen offset:64 sc0 sc1
s_mov_b64 exec, -1
s_lshl_b32 s76, s73, 7
s_add_u32 s76, s76, 2097152
s_lshl_b32 s77, s74, 4
s_lshl_b32 s78, s75, 2
s_add_u32 s77, s77, s78
s_getreg_b32 s99, hwreg(HW_REG_XCC_ID)
s_and_b32 s99, s99, 7
s_lshl_b32 s99, s99, 24
v_mov_b32 v58, s77
s_waitcnt vmcnt(0)
v_readfirstlane_b32 s98, v126
s_nop 0
s_add_u32 s98, s98, 1
s_add_u32 s99, s99, s98
v_mov_b32 v59, s99
s_mov_b64 exec, 1
buffer_store_dword v59, v58, s[60:63], s76 offen sc0 sc1
s_mov_b64 exec, -1
s_cmp_eq_u32 s75, 0
s_cbranch_scc0 L_svc_done
s_mov_b64 exec, 0xffffffff
s_mov_b32 s83, 0
L8:
buffer_load_dword v60, v3, s[60:63], s76 offen sc1
s_waitcnt vmcnt(0)
v_subrev_u32 v60, s98, v60
v_and_b32 v60, 0xf8ffffff, v60
v_cmp_ne_u32 vcc, 0, v60
s_cbranch_vccz L9
s_add_u32 s83, s83, 1
s_cmp_gt_u32 s83, 1048576
s_cbranch_scc0 L8
L9:
s_mov_b64 exec, -1
s_lshl_b32 s76, s2, 12
buffer_load_dwordx4 v[64:67], v2, s[60:63], s76 offen offset:0 sc1
buffer_load_dwordx4 v[68:71], v2, s[60:63], s76 offen offset:1024 sc1
buffer_load_dwordx4 v[72:75], v2, s[60:63], s76 offen offset:2048 sc1
buffer_load_dwordx4 v[76:79], v2, s[60:63], s76 offen offset:3072 sc1
v_and_b32 v58, 31, v1
v_lshlrev_b32 v58, 3, v58
v_add_u32 v58, 149760, v58
s_waitcnt vmcnt(0)
v_pk_add_f32 v[64:65], v[64:65], v[68:69]
v_pk_add_f32 v[72:73], v[72:73], v[76:77]
v_pk_add_f32 v[66:67], v[66:67], v[70:71]
v_pk_add_f32 v[74:75], v[74:75], v[78:79]
v_pk_add_f32 v[64:65], v[64:65], v[72:73]
v_pk_add_f32 v[66:67], v[66:67], v[74:75]
v_mov_b32 v68, v64
v_mov_b32 v69, v65
v_mov_b32 v70, v66
v_mov_b32 v71, v67
v_permlane32_swap_b32 v64, v68
v_permlane32_swap_b32 v65, v69
v_permlane32_swap_b32 v66, v70
v_permlane32_swap_b32 v67, v71
v_pk_add_f32 v[64:65], v[64:65], v[68:69]
v_pk_add_f32 v[66:67], v[66:67], v[70:71]
v_cvt_pk_bf16_f32 v64, v64, v65
v_cvt_pk_bf16_f32 v65, v66, v67
ds_write_b64 v58, v[64:65]
s_waitcnt lgkmcnt(0)
s_mov_b64 exec, 1
v_mov_b32 v124, 150028
v_mov_b32 v125, 1
ds_add_u32 v124, v125
s_mov_b64 exec, -1
s_mov_b32 s76, 2097152
s_mov_b32 s83, 0
L10:
buffer_load_dwordx4 v[64:67], v2, s[60:63], s76 offen offset:0 sc1
buffer_load_dwordx4 v[68:71], v2, s[60:63], s76 offen offset:1024 sc1
buffer_load_dwordx4 v[72:75], v2, s[60:63], s76 offen offset:2048 sc1
buffer_load_dwordx4 v[76:79], v2, s[60:63], s76 offen offset:3072 sc1
s_waitcnt vmcnt(0)
v_subrev_u32 v64, s98, v64
v_subrev_u32 v65, s98, v65
v_subrev_u32 v66, s98, v66
v_subrev_u32 v67, s98, v67
v_subrev_u32 v68, s98, v68
v_subrev_u32 v69, s98, v69
v_subrev_u32 v70, s98, v70
v_subrev_u32 v71, s98, v71
v_subrev_u32 v72, s98, v72
v_subrev_u32 v73, s98, v73
v_subrev_u32 v74, s98, v74
v_subrev_u32 v75, s98, v75
v_subrev_u32 v76, s98, v76
v_subrev_u32 v77, s98, v77
v_subrev_u32 v78, s98, v78
v_subrev_u32 v79, s98, v79
v_and_b32 v80, 0xf8ffffff, v64
v_and_b32 v81, 0xf8ffffff, v65
v_and_b32 v82, 0xf8ffffff, v66
v_and_b32 v83, 0xf8ffffff, v67
v_and_b32 v84, 0xf8ffffff, v68
v_and_b32 v85, 0xf8ffffff, v69
v_and_b32 v86, 0xf8ffffff, v70
v_and_b32 v87, 0xf8ffffff, v71
v_and_b32 v88, 0xf8ffffff, v72
v_and_b32 v89, 0xf8ffffff, v73
v_and_b32 v90, 0xf8ffffff, v74
v_and_b32 v91, 0xf8ffffff, v75
v_and_b32 v92, 0xf8ffffff, v76
v_and_b32 v93, 0xf8ffffff, v77
v_and_b32 v94, 0xf8ffffff, v78
v_and_b32 v95, 0xf8ffffff, v79
v_max3_u32 v60, v80, v81, v82
v_max3_u32 v60, v60, v83, v84
v_max3_u32 v60, v60, v85, v86
v_max3_u32 v60, v60, v87, v88
v_max3_u32 v60, v60, v89, v90
v_max3_u32 v60, v60, v91, v92
v_max3_u32 v60, v60, v93, v94
v_max_u32 v60, v60, v95
v_cmp_ne_u32 vcc, 0, v60
s_cbranch_vccz L11
s_add_u32 s83, s83, 1
s_cmp_gt_u32 s83, 1048576
s_cbranch_scc1 L11
s_sleep 16
s_branch L10
L11:
v_add_u32 v60, 155648, v3
ds_write_b32 v60, v64 offset:0
ds_write_b32 v60, v68 offset:256
ds_write_b32 v60, v72 offset:512
ds_write_b32 v60, v76 offset:768
s_waitcnt lgkmcnt(0)
v_and_b32 v4, 31, v1
v_lshlrev_b32 v4, 5, v4
s_lshl_b32 s81, s74, 2
s_add_u32 s81, s81, 155648
v_add_u32 v4, s81, v4
ds_read_b32 v5, v4
s_waitcnt lgkmcnt(0)
v_readfirstlane_b32 s87, v5
s_nop 1
v_cmp_ne_u32 vcc, s87, v5
s_nop 0
s_cmp_eq_u64 vcc, 0
s_cselect_b32 s87, 1, 0
s_cmp_eq_u32 s87, 1
s_cbranch_scc0 L15
s_mov_b32 s76, 2
v_mov_b32 v60, 150032
v_mov_b32 v61, 150036
v_mov_b32 v62, 1
s_lshl_b32 s79, s73, 2
v_mov_b32 v63, s79
L12:
s_mov_b32 s83, 0
L13:
ds_read_b32 v64, v60
s_waitcnt lgkmcnt(0)
v_readfirstlane_b32 s77, v64
s_nop 0
s_cmp_gt_u32 s77, s76
s_cbranch_scc1 L14
s_add_u32 s83, s83, 1
s_cmp_gt_u32 s83, 1048576
s_cbranch_scc1 L14
s_sleep 8
s_branch L13
L14:
s_sub_u32 s77, s77, 1
s_min_u32 s76, s77, 13
s_lshl_b32 s78, s76, 10
s_lshl_b32 s80, s74, 7
s_add_u32 s78, s78, s80
s_add_u32 s78, s78, 1703936
s_mov_b64 exec, 1
buffer_store_dword v62, v63, s[60:63], s78 offen
s_mov_b64 exec, 0xffffffff
buffer_load_dword v64, v3, s[60:63], s78 offen sc1
s_waitcnt vmcnt(0)
v_cmp_ne_u32 vcc, -1, v64
s_mov_b64 exec, -1
s_bcnt1_i32_b64 s80, vcc
s_mov_b32 s81, 5
s_cmp_gt_u32 s80, 16
s_addc_u32 s81, s81, 0
s_min_u32 s81, s81, 6
v_mov_b32 v64, s81
ds_write_b32 v61, v64
s_add_u32 s76, s76, 1
s_cmp_le_u32 s76, 13
s_cbranch_scc1 L12
s_waitcnt lgkmcnt(0)
L15:
s_barrier
s_barrier
s_cmp_eq_u32 s87, 1
s_cbranch_scc0 L19
s_mov_b32 s76, 16
v_mov_b32 v60, 150032
v_mov_b32 v61, 150036
v_mov_b32 v62, 1
s_lshl_b32 s79, s73, 2
v_mov_b32 v63, s79
L16:
s_mov_b32 s83, 0
L17:
ds_read_b32 v64, v60
s_waitcnt lgkmcnt(0)
v_readfirstlane_b32 s77, v64
s_nop 0
s_cmp_gt_u32 s77, s76
s_cbranch_scc1 L18
s_add_u32 s83, s83, 1
s_cmp_gt_u32 s83, 1048576
s_cbranch_scc1 L18
s_sleep 8
s_branch L17
L18:
s_sub_u32 s77, s77, 1
s_min_u32 s76, s77, 27
s_lshl_b32 s78, s76, 10
s_lshl_b32 s80, s74, 7
s_add_u32 s78, s78, s80
s_add_u32 s78, s78, 1703936
s_mov_b64 exec, 1
buffer_store_dword v62, v63, s[60:63], s78 offen
s_mov_b64 exec, 0xffffffff
buffer_load_dword v64, v3, s[60:63], s78 offen sc1
s_waitcnt vmcnt(0)
v_cmp_ne_u32 vcc, -1, v64
s_mov_b64 exec, -1
s_bcnt1_i32_b64 s80, vcc
s_mov_b32 s81, 5
s_cmp_gt_u32 s80, 16
s_addc_u32 s81, s81, 0
s_min_u32 s81, s81, 6
v_mov_b32 v64, s81
ds_write_b32 v61, v64
s_add_u32 s76, s76, 1
s_cmp_le_u32 s76, 27
s_cbranch_scc1 L16
s_waitcnt lgkmcnt(0)
L19:
s_branch L_join3
L_svc_done:
s_barrier
s_barrier
s_branch L_join3
L_stream:
v_lshrrev_b32 v4, 3, v1
v_and_b32 v5, 7, v1
v_lshrrev_b32 v6, 4, v1
v_and_b32 v6, 1, v6
v_lshlrev_b32 v6, 1, v6
v_xor_b32 v5, v5, v6
s_and_b32 s76, s75, 1
s_lshl_b32 s76, s76, 2
v_xor_b32 v5, s76, v5
v_lshlrev_b32 v5, 4, v5
s_waitcnt lgkmcnt(0)
s_mov_b32 s60, s38
s_mov_b32 s61, s39
s_mov_b32 s62, 6291456
s_mov_b32 s63, 0x20000
s_mov_b32 s100, 999
s_mov_b32 s101, 0
s_cmp_ge_u32 s73, 8
s_cbranch_scc1 L20
s_mov_b32 s86, 0
s_mov_b32 s51, 24
s_mov_b32 s84, 2048
s_mov_b32 s85, 32
s_lshr_b32 s76, s73, 1
s_lshl_b32 s76, s76, 21
s_and_b32 s77, s73, 1
s_lshl_b32 s78, s74, 1
s_add_u32 s77, s77, s78
s_lshl_b32 s77, s77, 7
s_add_u32 s76, s76, s77
s_add_u32 s56, s24, s76
s_addc_u32 s57, s25, 0
s_sub_u32 s58, 8388608, s76
s_branch L23
L20:
s_cmp_ge_u32 s73, 22
s_cbranch_scc1 L21
s_mov_b32 s86, 1
s_mov_b32 s51, 12
s_mov_b32 s84, 7168
s_mov_b32 s85, 32
s_sub_u32 s76, s73, 8
s_lshr_b32 s77, s76, 1
s_mul_i32 s78, s74, 7
s_add_u32 s77, s77, s78
s_lshl_b32 s77, s77, 7
s_bitcmp1_b32 s76, 0
s_cselect_b32 s78, s30, s28
s_cselect_b32 s79, s31, s29
s_add_u32 s56, s78, s77
s_addc_u32 s57, s79, 0
s_sub_u32 s58, 7340032, s77
s_branch L23
L21:
s_cmp_ge_u32 s73, 30
s_cbranch_scc1 L22
s_mov_b32 s86, 2
s_mov_b32 s51, 12
s_mov_b32 s84, 2048
s_mov_b32 s85, 28
s_mov_b32 s100, 14
s_mov_b32 s101, 4294049920
s_mul_i32 s77, s74, 917504
s_sub_u32 s76, s73, 22
s_lshl_b32 s76, s76, 8
s_add_u32 s76, s76, s77
s_add_u32 s56, s32, s76
s_addc_u32 s57, s33, 0
s_sub_u32 s58, 7340032, s76
s_branch L23
L22:
s_mov_b32 s86, 3
s_mov_b32 s51, 0
s_mov_b32 s84, 2048
s_mov_b32 s85, 0
s_mov_b32 s56, s32
s_mov_b32 s57, s33
s_mov_b32 s58, 0
L23:
s_mov_b32 s59, 0x20000
s_lshl_b32 s76, s74, 5
s_add_u32 s76, s76, s73
s_lshl_b32 s76, s76, 20
s_add_u32 s40, s18, s76
s_addc_u32 s41, s19, 0
s_mov_b32 s42, 1048576
s_mov_b32 s43, 0x20000
s_add_u32 s44, s20, s76
s_addc_u32 s45, s21, 0
s_mov_b32 s46, 1048576
s_mov_b32 s47, 0x20000
v_mul_lo_u32 v4, v4, s84
v_add_u32 v4, v4, v5
s_lshl_b32 s76, s84, 3
s_mul_i32 s77, s76, s75
s_lshl_b32 s76, s76, 2
s_lshl_b32 s78, s75, 10
s_mov_b32 s79, 0
s_barrier
s_cmp_eq_u32 s51, 0
s_cbranch_scc1 L26
L24:
s_mov_b32 m0, s78
s_waitcnt vmcnt(7)
buffer_load_dwordx4 v4, s[56:59], s77 offen nt lds
s_add_u32 s77, s77, s76
s_add_u32 s78, s78, 4096
s_add_u32 s79, s79, 1
s_cmp_eq_u32 s79, s100
s_cselect_b32 s80, s101, 0
s_add_u32 s77, s77, s80
s_cmp_lt_u32 s79, s51
s_cbranch_scc1 L24
L26:
s_mov_b32 s50, 0
s_lshl_b32 s81, s75, 10
s_add_u32 s50, s50, s81
s_mov_b32 s82, s50
s_waitcnt vmcnt(7)
buffer_load_dwordx4 v[64:67], v2, s[40:43], s82 offen nt
s_add_u32 s82, s82, 4096
s_waitcnt vmcnt(7)
buffer_load_dwordx4 v[68:71], v2, s[40:43], s82 offen nt
s_add_u32 s82, s82, 4096
s_waitcnt vmcnt(7)
buffer_load_dwordx4 v[72:75], v2, s[40:43], s82 offen nt
s_add_u32 s82, s82, 4096
s_waitcnt vmcnt(7)
buffer_load_dwordx4 v[76:79], v2, s[40:43], s82 offen nt
s_add_u32 s82, s82, 4096
s_waitcnt vmcnt(7)
buffer_load_dwordx4 v[80:83], v2, s[40:43], s82 offen nt
s_add_u32 s82, s82, 4096
s_waitcnt vmcnt(7)
buffer_load_dwordx4 v[84:87], v2, s[40:43], s82 offen nt
s_add_u32 s82, s82, 4096
s_waitcnt vmcnt(7)
buffer_load_dwordx4 v[88:91], v2, s[40:43], s82 offen nt
s_add_u32 s82, s82, 4096
s_waitcnt vmcnt(7)
buffer_load_dwordx4 v[92:95], v2, s[40:43], s82 offen nt
s_add_u32 s82, s82, 4096
s_waitcnt vmcnt(7)
buffer_load_dwordx4 v[96:99], v2, s[40:43], s82 offen nt
s_add_u32 s82, s82, 4096
s_waitcnt vmcnt(7)
buffer_load_dwordx4 v[100:103], v2, s[40:43], s82 offen nt
s_add_u32 s82, s82, 4096
s_waitcnt vmcnt(7)
buffer_load_dwordx4 v[104:107], v2, s[40:43], s82 offen nt
s_add_u32 s82, s82, 4096
s_waitcnt vmcnt(7)
buffer_load_dwordx4 v[108:111], v2, s[40:43], s82 offen nt
s_add_u32 s82, s82, 4096
s_waitcnt vmcnt(7)
buffer_load_dwordx4 v[112:115], v2, s[40:43], s82 offen nt
s_add_u32 s82, s82, 4096
s_waitcnt vmcnt(7)
buffer_load_dwordx4 v[116:119], v2, s[40:43], s82 offen nt
s_add_u32 s82, s82, 4096
s_waitcnt vmcnt(7)
buffer_load_dwordx4 v[120:123], v2, s[40:43], s82 offen nt
s_add_u32 s82, s82, 4096
s_waitcnt vmcnt(7)
buffer_load_dwordx4 v[124:127], v2, s[40:43], s82 offen nt
s_add_u32 s82, s82, 4096
s_waitcnt vmcnt(7)
buffer_load_dwordx4 v[128:131], v2, s[40:43], s82 offen nt
s_add_u32 s82, s82, 4096
s_waitcnt vmcnt(7)
buffer_load_dwordx4 v[132:135], v2, s[40:43], s82 offen nt
s_add_u32 s82, s82, 4096
s_waitcnt vmcnt(7)
buffer_load_dwordx4 v[136:139], v2, s[40:43], s82 offen nt
s_add_u32 s82, s82, 4096
s_waitcnt vmcnt(7)
buffer_load_dwordx4 v[140:143], v2, s[40:43], s82 offen nt
s_add_u32 s82, s82, 4096
s_waitcnt vmcnt(7)
buffer_load_dwordx4 v[144:147], v2, s[40:43], s82 offen nt
s_add_u32 s82, s82, 4096
s_waitcnt vmcnt(7)
buffer_load_dwordx4 v[148:151], v2, s[40:43], s82 offen nt
s_add_u32 s82, s82, 4096
s_waitcnt vmcnt(7)
buffer_load_dwordx4 v[152:155], v2, s[40:43], s82 offen nt
s_add_u32 s82, s82, 4096
s_waitcnt vmcnt(7)
buffer_load_dwordx4 v[156:159], v2, s[40:43], s82 offen nt
s_add_u32 s82, s82, 4096
s_waitcnt vmcnt(7)
buffer_load_dwordx4 v[160:163], v2, s[40:43], s82 offen nt
s_add_u32 s82, s82, 4096
s_waitcnt vmcnt(7)
buffer_load_dwordx4 v[164:167], v2, s[40:43], s82 offen nt
s_add_u32 s82, s82, 4096
s_waitcnt vmcnt(7)
buffer_load_dwordx4 v[168:171], v2, s[40:43], s82 offen nt
s_add_u32 s82, s82, 4096
s_waitcnt vmcnt(7)
buffer_load_dwordx4 v[172:175], v2, s[40:43], s82 offen nt
s_add_u32 s82, s82, 4096
s_waitcnt vmcnt(7)
buffer_load_dwordx4 v[176:179], v2, s[40:43], s82 offen nt
s_add_u32 s82, s82, 4096
s_waitcnt vmcnt(7)
buffer_load_dwordx4 v[180:183], v2, s[40:43], s82 offen nt
s_add_u32 s82, s82, 4096
s_waitcnt vmcnt(7)
buffer_load_dwordx4 v[184:187], v2, s[40:43], s82 offen nt
s_add_u32 s82, s82, 4096
s_waitcnt vmcnt(7)
buffer_load_dwordx4 v[188:191], v2, s[40:43], s82 offen nt
s_add_u32 s82, s82, 4096
s_cmp_eq_u32 s86, 0
s_cbranch_scc0 L27
v_mov_b32 v6, 150020
s_mov_b32 s83, 0
L28:
ds_read_b32 v7, v6
s_waitcnt lgkmcnt(0)
v_readfirstlane_b32 s81, v7
s_nop 0
s_cmp_ge_u32 s81, 4
s_cbranch_scc1 L29
s_add_u32 s83, s83, 1
s_cmp_gt_u32 s83, 4194304
s_cbranch_scc1 L29
s_sleep 1
s_branch L28
L29:
L25:
s_mov_b32 m0, s78
s_waitcnt vmcnt(7)
buffer_load_dwordx4 v4, s[56:59], s77 offen nt lds
s_add_u32 s77, s77, s76
s_add_u32 s78, s78, 4096
s_add_u32 s79, s79, 1
s_cmp_eq_u32 s79, s100
s_cselect_b32 s80, s101, 0
s_add_u32 s77, s77, s80
s_cmp_lt_u32 s79, s85
s_cbranch_scc1 L25
L27:
s_mov_b32 s52, s77
s_mov_b32 s53, s78
s_mov_b32 s54, s79
s_mov_b32 s55, s76
v_mov_b32 v204, v4
v_mov_b32 v6, 150028
s_mov_b32 s83, 0
L30:
ds_read_b32 v7, v6
s_waitcnt lgkmcnt(0)
v_readfirstlane_b32 s81, v7
s_nop 0
s_cmp_ge_u32 s81, 1
s_cbranch_scc1 L31
s_add_u32 s83, s83, 1
s_cmp_gt_u32 s83, 4194304
s_cbranch_scc1 L31
s_sleep 1
s_branch L30
L31:
v_and_b32 v6, 15, v1
v_lshlrev_b32 v6, 4, v6
v_add_u32 v6, 149760, v6
ds_read_b128 v[8:11], v6
v_mov_b32 v24, 0xff800000
v_and_b32 v6, 3, v1
v_lshlrev_b32 v6, 2, v6
v_bfe_u32 v7, v1, 2, 1
v_lshlrev_b32 v7, 1, v7
v_bfe_u32 v5, v1, 3, 1
v_or_b32 v7, v7, v5
v_add_u32 v6, v6, v7
v_and_b32 v7, 48, v1
v_add_u32 v6, v6, v7
v_lshlrev_b32 v6, 2, v6
s_lshl_b32 s76, s75, 12
s_add_u32 s76, s76, 131072
v_add_u32 v25, s76, v6
v_mov_b32 v201, 150036
v_mov_b32 v202, 0
v_mov_b32 v203, 150032
ds_read_b32 v200, v201
s_waitcnt lgkmcnt(0)
s_waitcnt lgkmcnt(0)
v_readfirstlane_b32 s3, v200
ds_read_b32 v200, v201
s_waitcnt vmcnt(31)
v_dot2_f32_bf16 v12, v64, v8, 0
v_dot2_f32_bf16 v12, v65, v9, v12
v_dot2_f32_bf16 v12, v66, v10, v12
v_dot2_f32_bf16 v12, v67, v11, v12
s_waitcnt vmcnt(30)
v_dot2_f32_bf16 v13, v68, v8, 0
v_dot2_f32_bf16 v13, v69, v9, v13
v_dot2_f32_bf16 v13, v70, v10, v13
v_dot2_f32_bf16 v13, v71, v11, v13
s_waitcnt vmcnt(29)
v_dot2_f32_bf16 v14, v72, v8, 0
v_dot2_f32_bf16 v14, v73, v9, v14
v_dot2_f32_bf16 v14, v74, v10, v14
v_dot2_f32_bf16 v14, v75, v11, v14
s_waitcnt vmcnt(28)
v_dot2_f32_bf16 v15, v76, v8, 0
v_dot2_f32_bf16 v15, v77, v9, v15
v_dot2_f32_bf16 v15, v78, v10, v15
v_dot2_f32_bf16 v15, v79, v11, v15
v_add_f32_dpp v16, v12, v12 row_ror:8 row_mask:0xf bank_mask:0x3
v_add_f32_dpp v17, v14, v14 row_ror:8 row_mask:0xf bank_mask:0x3
s_nop 0
v_add_f32_dpp v16, v13, v13 row_ror:8 row_mask:0xf bank_mask:0xc
v_add_f32_dpp v17, v15, v15 row_ror:8 row_mask:0xf bank_mask:0xc
s_nop 0
v_add_f32_dpp v18, v16, v16 row_half_mirror row_mask:0xf bank_mask:0x5
s_nop 1
v_add_f32_dpp v18, v17, v17 row_half_mirror row_mask:0xf bank_mask:0xa
s_nop 1
v_add_f32_dpp v18, v18, v18 quad_perm:[1,0,3,2] row_mask:0xf bank_mask:0xf
s_nop 1
v_add_f32_dpp v18, v18, v18 quad_perm:[2,3,0,1] row_mask:0xf bank_mask:0xf
s_waitcnt vmcnt(27)
v_dot2_f32_bf16 v12, v80, v8, 0
v_dot2_f32_bf16 v12, v81, v9, v12
v_dot2_f32_bf16 v12, v82, v10, v12
v_dot2_f32_bf16 v12, v83, v11, v12
s_waitcnt vmcnt(26)
v_dot2_f32_bf16 v13, v84, v8, 0
v_dot2_f32_bf16 v13, v85, v9, v13
v_dot2_f32_bf16 v13, v86, v10, v13
v_dot2_f32_bf16 v13, v87, v11, v13
s_waitcnt vmcnt(25)
v_dot2_f32_bf16 v14, v88, v8, 0
v_dot2_f32_bf16 v14, v89, v9, v14
v_dot2_f32_bf16 v14, v90, v10, v14
v_dot2_f32_bf16 v14, v91, v11, v14
s_waitcnt vmcnt(24)
v_dot2_f32_bf16 v15, v92, v8, 0
v_dot2_f32_bf16 v15, v93, v9, v15
v_dot2_f32_bf16 v15, v94, v10, v15
v_dot2_f32_bf16 v15, v95, v11, v15
v_add_f32_dpp v16, v12, v12 row_ror:8 row_mask:0xf bank_mask:0x3
v_add_f32_dpp v17, v14, v14 row_ror:8 row_mask:0xf bank_mask:0x3
s_nop 0
v_add_f32_dpp v16, v13, v13 row_ror:8 row_mask:0xf bank_mask:0xc
v_add_f32_dpp v17, v15, v15 row_ror:8 row_mask:0xf bank_mask:0xc
s_nop 0
v_add_f32_dpp v19, v16, v16 row_half_mirror row_mask:0xf bank_mask:0x5
s_nop 1
v_add_f32_dpp v19, v17, v17 row_half_mirror row_mask:0xf bank_mask:0xa
s_nop 1
v_add_f32_dpp v19, v19, v19 quad_perm:[1,0,3,2] row_mask:0xf bank_mask:0xf
s_nop 1
v_add_f32_dpp v19, v19, v19 quad_perm:[2,3,0,1] row_mask:0xf bank_mask:0xf
s_waitcnt vmcnt(23)
v_dot2_f32_bf16 v12, v96, v8, 0
v_dot2_f32_bf16 v12, v97, v9, v12
v_dot2_f32_bf16 v12, v98, v10, v12
v_dot2_f32_bf16 v12, v99, v11, v12
s_waitcnt vmcnt(22)
v_dot2_f32_bf16 v13, v100, v8, 0
v_dot2_f32_bf16 v13, v101, v9, v13
v_dot2_f32_bf16 v13, v102, v10, v13
v_dot2_f32_bf16 v13, v103, v11, v13
s_waitcnt vmcnt(21)
v_dot2_f32_bf16 v14, v104, v8, 0
v_dot2_f32_bf16 v14, v105, v9, v14
v_dot2_f32_bf16 v14, v106, v10, v14
v_dot2_f32_bf16 v14, v107, v11, v14
s_waitcnt vmcnt(20)
v_dot2_f32_bf16 v15, v108, v8, 0
v_dot2_f32_bf16 v15, v109, v9, v15
v_dot2_f32_bf16 v15, v110, v10, v15
v_dot2_f32_bf16 v15, v111, v11, v15
v_add_f32_dpp v16, v12, v12 row_ror:8 row_mask:0xf bank_mask:0x3
v_add_f32_dpp v17, v14, v14 row_ror:8 row_mask:0xf bank_mask:0x3
s_nop 0
v_add_f32_dpp v16, v13, v13 row_ror:8 row_mask:0xf bank_mask:0xc
v_add_f32_dpp v17, v15, v15 row_ror:8 row_mask:0xf bank_mask:0xc
s_nop 0
v_add_f32_dpp v20, v16, v16 row_half_mirror row_mask:0xf bank_mask:0x5
s_nop 1
v_add_f32_dpp v20, v17, v17 row_half_mirror row_mask:0xf bank_mask:0xa
s_nop 1
v_add_f32_dpp v20, v20, v20 quad_perm:[1,0,3,2] row_mask:0xf bank_mask:0xf
s_nop 1
v_add_f32_dpp v20, v20, v20 quad_perm:[2,3,0,1] row_mask:0xf bank_mask:0xf
s_waitcnt vmcnt(19)
v_dot2_f32_bf16 v12, v112, v8, 0
v_dot2_f32_bf16 v12, v113, v9, v12
v_dot2_f32_bf16 v12, v114, v10, v12
v_dot2_f32_bf16 v12, v115, v11, v12
s_waitcnt vmcnt(18)
v_dot2_f32_bf16 v13, v116, v8, 0
v_dot2_f32_bf16 v13, v117, v9, v13
v_dot2_f32_bf16 v13, v118, v10, v13
v_dot2_f32_bf16 v13, v119, v11, v13
s_waitcnt vmcnt(17)
v_dot2_f32_bf16 v14, v120, v8, 0
v_dot2_f32_bf16 v14, v121, v9, v14
v_dot2_f32_bf16 v14, v122, v10, v14
v_dot2_f32_bf16 v14, v123, v11, v14
s_waitcnt vmcnt(16)
v_dot2_f32_bf16 v15, v124, v8, 0
v_dot2_f32_bf16 v15, v125, v9, v15
v_dot2_f32_bf16 v15, v126, v10, v15
v_dot2_f32_bf16 v15, v127, v11, v15
v_add_f32_dpp v16, v12, v12 row_ror:8 row_mask:0xf bank_mask:0x3
v_add_f32_dpp v17, v14, v14 row_ror:8 row_mask:0xf bank_mask:0x3
s_nop 0
v_add_f32_dpp v16, v13, v13 row_ror:8 row_mask:0xf bank_mask:0xc
v_add_f32_dpp v17, v15, v15 row_ror:8 row_mask:0xf bank_mask:0xc
s_nop 0
v_add_f32_dpp v21, v16, v16 row_half_mirror row_mask:0xf bank_mask:0x5
s_nop 1
v_add_f32_dpp v21, v17, v17 row_half_mirror row_mask:0xf bank_mask:0xa
s_nop 1
v_add_f32_dpp v21, v21, v21 quad_perm:[1,0,3,2] row_mask:0xf bank_mask:0xf
s_nop 1
v_add_f32_dpp v21, v21, v21 quad_perm:[2,3,0,1] row_mask:0xf bank_mask:0xf
v_cndmask_b32 v22, v18, v19, s[88:89]
v_cndmask_b32 v22, v22, v20, s[90:91]
v_cndmask_b32 v22, v22, v21, s[92:93]
v_cvt_pk_bf16_f32 v22, v22, v22
v_lshlrev_b32 v22, 16, v22
v_mul_f32 v22, 0x3db504f3, v22
v_cvt_pk_bf16_f32 v22, v22, v22
v_lshlrev_b32 v22, 16, v22
ds_write_b32 v25, v22
v_max_f32 v24, v24, v22
v_add_u32 v25, 256, v25
v_add_u32 v202, 1, v202
s_cmp_eq_u32 s75, 0
s_cbranch_scc0 L32
ds_write_b32 v203, v202
L32:
s_waitcnt lgkmcnt(0)
v_readfirstlane_b32 s3, v200
ds_read_b32 v200, v201
s_waitcnt vmcnt(15)
v_dot2_f32_bf16 v12, v128, v8, 0
v_dot2_f32_bf16 v12, v129, v9, v12
v_dot2_f32_bf16 v12, v130, v10, v12
v_dot2_f32_bf16 v12, v131, v11, v12
s_waitcnt vmcnt(14)
v_dot2_f32_bf16 v13, v132, v8, 0
v_dot2_f32_bf16 v13, v133, v9, v13
v_dot2_f32_bf16 v13, v134, v10, v13
v_dot2_f32_bf16 v13, v135, v11, v13
s_waitcnt vmcnt(13)
v_dot2_f32_bf16 v14, v136, v8, 0
v_dot2_f32_bf16 v14, v137, v9, v14
v_dot2_f32_bf16 v14, v138, v10, v14
v_dot2_f32_bf16 v14, v139, v11, v14
s_waitcnt vmcnt(12)
v_dot2_f32_bf16 v15, v140, v8, 0
v_dot2_f32_bf16 v15, v141, v9, v15
v_dot2_f32_bf16 v15, v142, v10, v15
v_dot2_f32_bf16 v15, v143, v11, v15
v_add_f32_dpp v16, v12, v12 row_ror:8 row_mask:0xf bank_mask:0x3
v_add_f32_dpp v17, v14, v14 row_ror:8 row_mask:0xf bank_mask:0x3
s_nop 0
v_add_f32_dpp v16, v13, v13 row_ror:8 row_mask:0xf bank_mask:0xc
v_add_f32_dpp v17, v15, v15 row_ror:8 row_mask:0xf bank_mask:0xc
s_nop 0
v_add_f32_dpp v18, v16, v16 row_half_mirror row_mask:0xf bank_mask:0x5
s_nop 1
v_add_f32_dpp v18, v17, v17 row_half_mirror row_mask:0xf bank_mask:0xa
s_nop 1
v_add_f32_dpp v18, v18, v18 quad_perm:[1,0,3,2] row_mask:0xf bank_mask:0xf
s_nop 1
v_add_f32_dpp v18, v18, v18 quad_perm:[2,3,0,1] row_mask:0xf bank_mask:0xf
s_waitcnt vmcnt(11)
v_dot2_f32_bf16 v12, v144, v8, 0
v_dot2_f32_bf16 v12, v145, v9, v12
v_dot2_f32_bf16 v12, v146, v10, v12
v_dot2_f32_bf16 v12, v147, v11, v12
s_waitcnt vmcnt(10)
v_dot2_f32_bf16 v13, v148, v8, 0
v_dot2_f32_bf16 v13, v149, v9, v13
v_dot2_f32_bf16 v13, v150, v10, v13
v_dot2_f32_bf16 v13, v151, v11, v13
s_waitcnt vmcnt(9)
v_dot2_f32_bf16 v14, v152, v8, 0
v_dot2_f32_bf16 v14, v153, v9, v14
v_dot2_f32_bf16 v14, v154, v10, v14
v_dot2_f32_bf16 v14, v155, v11, v14
s_waitcnt vmcnt(8)
v_dot2_f32_bf16 v15, v156, v8, 0
v_dot2_f32_bf16 v15, v157, v9, v15
v_dot2_f32_bf16 v15, v158, v10, v15
v_dot2_f32_bf16 v15, v159, v11, v15
v_add_f32_dpp v16, v12, v12 row_ror:8 row_mask:0xf bank_mask:0x3
v_add_f32_dpp v17, v14, v14 row_ror:8 row_mask:0xf bank_mask:0x3
s_nop 0
v_add_f32_dpp v16, v13, v13 row_ror:8 row_mask:0xf bank_mask:0xc
v_add_f32_dpp v17, v15, v15 row_ror:8 row_mask:0xf bank_mask:0xc
s_nop 0
v_add_f32_dpp v19, v16, v16 row_half_mirror row_mask:0xf bank_mask:0x5
s_nop 1
v_add_f32_dpp v19, v17, v17 row_half_mirror row_mask:0xf bank_mask:0xa
s_nop 1
v_add_f32_dpp v19, v19, v19 quad_perm:[1,0,3,2] row_mask:0xf bank_mask:0xf
s_nop 1
v_add_f32_dpp v19, v19, v19 quad_perm:[2,3,0,1] row_mask:0xf bank_mask:0xf
s_waitcnt vmcnt(7)
v_dot2_f32_bf16 v12, v160, v8, 0
v_dot2_f32_bf16 v12, v161, v9, v12
v_dot2_f32_bf16 v12, v162, v10, v12
v_dot2_f32_bf16 v12, v163, v11, v12
s_waitcnt vmcnt(6)
v_dot2_f32_bf16 v13, v164, v8, 0
v_dot2_f32_bf16 v13, v165, v9, v13
v_dot2_f32_bf16 v13, v166, v10, v13
v_dot2_f32_bf16 v13, v167, v11, v13
s_waitcnt vmcnt(5)
s_cmp_ge_u32 s3, 6
s_cbranch_scc1 L33
s_waitcnt vmcnt(4)
L33:
buffer_load_dwordx4 v[64:67], v2, s[40:43], s82 offen nt
s_add_u32 s82, s82, 4096
v_dot2_f32_bf16 v14, v168, v8, 0
v_dot2_f32_bf16 v14, v169, v9, v14
v_dot2_f32_bf16 v14, v170, v10, v14
v_dot2_f32_bf16 v14, v171, v11, v14
s_waitcnt vmcnt(5)
s_cmp_ge_u32 s3, 6
s_cbranch_scc1 L34
s_waitcnt vmcnt(4)
L34:
buffer_load_dwordx4 v[68:71], v2, s[40:43], s82 offen nt
s_add_u32 s82, s82, 4096
v_dot2_f32_bf16 v15, v172, v8, 0
v_dot2_f32_bf16 v15, v173, v9, v15
v_dot2_f32_bf16 v15, v174, v10, v15
v_dot2_f32_bf16 v15, v175, v11, v15
v_add_f32_dpp v16, v12, v12 row_ror:8 row_mask:0xf bank_mask:0x3
v_add_f32_dpp v17, v14, v14 row_ror:8 row_mask:0xf bank_mask:0x3
s_nop 0
v_add_f32_dpp v16, v13, v13 row_ror:8 row_mask:0xf bank_mask:0xc
v_add_f32_dpp v17, v15, v15 row_ror:8 row_mask:0xf bank_mask:0xc
s_nop 0
v_add_f32_dpp v20, v16, v16 row_half_mirror row_mask:0xf bank_mask:0x5
s_nop 1
v_add_f32_dpp v20, v17, v17 row_half_mirror row_mask:0xf bank_mask:0xa
s_nop 1
v_add_f32_dpp v20, v20, v20 quad_perm:[1,0,3,2] row_mask:0xf bank_mask:0xf
s_nop 1
v_add_f32_dpp v20, v20, v20 quad_perm:[2,3,0,1] row_mask:0xf bank_mask:0xf
s_waitcnt vmcnt(5)
s_cmp_ge_u32 s3, 6
s_cbranch_scc1 L35
s_waitcnt vmcnt(4)
L35:
buffer_load_dwordx4 v[72:75], v2, s[40:43], s82 offen nt
s_add_u32 s82, s82, 4096
v_dot2_f32_bf16 v12, v176, v8, 0
v_dot2_f32_bf16 v12, v177, v9, v12
v_dot2_f32_bf16 v12, v178, v10, v12
v_dot2_f32_bf16 v12, v179, v11, v12
s_waitcnt vmcnt(5)
s_cmp_ge_u32 s3, 6
s_cbranch_scc1 L36
s_waitcnt vmcnt(4)
L36:
buffer_load_dwordx4 v[76:79], v2, s[40:43], s82 offen nt
s_add_u32 s82, s82, 4096
v_dot2_f32_bf16 v13, v180, v8, 0
v_dot2_f32_bf16 v13, v181, v9, v13
v_dot2_f32_bf16 v13, v182, v10, v13
v_dot2_f32_bf16 v13, v183, v11, v13
s_waitcnt vmcnt(5)
s_cmp_ge_u32 s3, 6
s_cbranch_scc1 L37
s_waitcnt vmcnt(4)
L37:
buffer_load_dwordx4 v[80:83], v2, s[40:43], s82 offen nt
s_add_u32 s82, s82, 4096
v_dot2_f32_bf16 v14, v184, v8, 0
v_dot2_f32_bf16 v14, v185, v9, v14
v_dot2_f32_bf16 v14, v186, v10, v14
v_dot2_f32_bf16 v14, v187, v11, v14
s_waitcnt vmcnt(5)
s_cmp_ge_u32 s3, 6
s_cbranch_scc1 L38
s_waitcnt vmcnt(4)
L38:
buffer_load_dwordx4 v[84:87], v2, s[40:43], s82 offen nt
s_add_u32 s82, s82, 4096
v_dot2_f32_bf16 v15, v188, v8, 0
v_dot2_f32_bf16 v15, v189, v9, v15
v_dot2_f32_bf16 v15, v190, v10, v15
v_dot2_f32_bf16 v15, v191, v11, v15
v_add_f32_dpp v16, v12, v12 row_ror:8 row_mask:0xf bank_mask:0x3
v_add_f32_dpp v17, v14, v14 row_ror:8 row_mask:0xf bank_mask:0x3
s_nop 0
v_add_f32_dpp v16, v13, v13 row_ror:8 row_mask:0xf bank_mask:0xc
v_add_f32_dpp v17, v15, v15 row_ror:8 row_mask:0xf bank_mask:0xc
s_nop 0
v_add_f32_dpp v21, v16, v16 row_half_mirror row_mask:0xf bank_mask:0x5
s_nop 1
v_add_f32_dpp v21, v17, v17 row_half_mirror row_mask:0xf bank_mask:0xa
s_nop 1
v_add_f32_dpp v21, v21, v21 quad_perm:[1,0,3,2] row_mask:0xf bank_mask:0xf
s_nop 1
v_add_f32_dpp v21, v21, v21 quad_perm:[2,3,0,1] row_mask:0xf bank_mask:0xf
v_cndmask_b32 v22, v18, v19, s[88:89]
v_cndmask_b32 v22, v22, v20, s[90:91]
v_cndmask_b32 v22, v22, v21, s[92:93]
v_cvt_pk_bf16_f32 v22, v22, v22
v_lshlrev_b32 v22, 16, v22
v_mul_f32 v22, 0x3db504f3, v22
v_cvt_pk_bf16_f32 v22, v22, v22
v_lshlrev_b32 v22, 16, v22
ds_write_b32 v25, v22
v_max_f32 v24, v24, v22
v_add_u32 v25, 256, v25
v_add_u32 v202, 1, v202
s_cmp_eq_u32 s75, 0
s_cbranch_scc0 L39
ds_write_b32 v203, v202
L39:
s_mov_b32 s79, 0
L40:
s_waitcnt lgkmcnt(0)
v_readfirstlane_b32 s3, v200
ds_read_b32 v200, v201
s_waitcnt vmcnt(5)
s_cmp_ge_u32 s3, 6
s_cbranch_scc1 L41
s_waitcnt vmcnt(4)
L41:
buffer_load_dwordx4 v[88:91], v2, s[40:43], s82 offen nt
s_add_u32 s82, s82, 4096
v_dot2_f32_bf16 v12, v64, v8, 0
v_dot2_f32_bf16 v12, v65, v9, v12
v_dot2_f32_bf16 v12, v66, v10, v12
v_dot2_f32_bf16 v12, v67, v11, v12
s_waitcnt vmcnt(5)
s_cmp_ge_u32 s3, 6
s_cbranch_scc1 L42
s_waitcnt vmcnt(4)
L42:
buffer_load_dwordx4 v[92:95], v2, s[40:43], s82 offen nt
s_add_u32 s82, s82, 4096
v_dot2_f32_bf16 v13, v68, v8, 0
v_dot2_f32_bf16 v13, v69, v9, v13
v_dot2_f32_bf16 v13, v70, v10, v13
v_dot2_f32_bf16 v13, v71, v11, v13
s_waitcnt vmcnt(5)
s_cmp_ge_u32 s3, 6
s_cbranch_scc1 L43
s_waitcnt vmcnt(4)
L43:
buffer_load_dwordx4 v[96:99], v2, s[40:43], s82 offen nt
s_add_u32 s82, s82, 4096
v_dot2_f32_bf16 v14, v72, v8, 0
v_dot2_f32_bf16 v14, v73, v9, v14
v_dot2_f32_bf16 v14, v74, v10, v14
v_dot2_f32_bf16 v14, v75, v11, v14
s_waitcnt vmcnt(5)
s_cmp_ge_u32 s3, 6
s_cbranch_scc1 L44
s_waitcnt vmcnt(4)
L44:
buffer_load_dwordx4 v[100:103], v2, s[40:43], s82 offen nt
s_add_u32 s82, s82, 4096
v_dot2_f32_bf16 v15, v76, v8, 0
v_dot2_f32_bf16 v15, v77, v9, v15
v_dot2_f32_bf16 v15, v78, v10, v15
v_dot2_f32_bf16 v15, v79, v11, v15
v_add_f32_dpp v16, v12, v12 row_ror:8 row_mask:0xf bank_mask:0x3
v_add_f32_dpp v17, v14, v14 row_ror:8 row_mask:0xf bank_mask:0x3
s_nop 0
v_add_f32_dpp v16, v13, v13 row_ror:8 row_mask:0xf bank_mask:0xc
v_add_f32_dpp v17, v15, v15 row_ror:8 row_mask:0xf bank_mask:0xc
s_nop 0
v_add_f32_dpp v18, v16, v16 row_half_mirror row_mask:0xf bank_mask:0x5
s_nop 1
v_add_f32_dpp v18, v17, v17 row_half_mirror row_mask:0xf bank_mask:0xa
s_nop 1
v_add_f32_dpp v18, v18, v18 quad_perm:[1,0,3,2] row_mask:0xf bank_mask:0xf
s_nop 1
v_add_f32_dpp v18, v18, v18 quad_perm:[2,3,0,1] row_mask:0xf bank_mask:0xf
s_waitcnt vmcnt(5)
s_cmp_ge_u32 s3, 6
s_cbranch_scc1 L45
s_waitcnt vmcnt(4)
L45:
buffer_load_dwordx4 v[104:107], v2, s[40:43], s82 offen nt
s_add_u32 s82, s82, 4096
v_dot2_f32_bf16 v12, v80, v8, 0
v_dot2_f32_bf16 v12, v81, v9, v12
v_dot2_f32_bf16 v12, v82, v10, v12
v_dot2_f32_bf16 v12, v83, v11, v12
s_waitcnt vmcnt(5)
s_cmp_ge_u32 s3, 6
s_cbranch_scc1 L46
s_waitcnt vmcnt(4)
L46:
buffer_load_dwordx4 v[108:111], v2, s[40:43], s82 offen nt
s_add_u32 s82, s82, 4096
v_dot2_f32_bf16 v13, v84, v8, 0
v_dot2_f32_bf16 v13, v85, v9, v13
v_dot2_f32_bf16 v13, v86, v10, v13
v_dot2_f32_bf16 v13, v87, v11, v13
s_waitcnt vmcnt(5)
s_cmp_ge_u32 s3, 6
s_cbranch_scc1 L47
s_waitcnt vmcnt(4)
L47:
buffer_load_dwordx4 v[112:115], v2, s[40:43], s82 offen nt
s_add_u32 s82, s82, 4096
v_dot2_f32_bf16 v14, v88, v8, 0
v_dot2_f32_bf16 v14, v89, v9, v14
v_dot2_f32_bf16 v14, v90, v10, v14
v_dot2_f32_bf16 v14, v91, v11, v14
s_waitcnt vmcnt(5)
s_cmp_ge_u32 s3, 6
s_cbranch_scc1 L48
s_waitcnt vmcnt(4)
L48:
buffer_load_dwordx4 v[116:119], v2, s[40:43], s82 offen nt
s_add_u32 s82, s82, 4096
v_dot2_f32_bf16 v15, v92, v8, 0
v_dot2_f32_bf16 v15, v93, v9, v15
v_dot2_f32_bf16 v15, v94, v10, v15
v_dot2_f32_bf16 v15, v95, v11, v15
v_add_f32_dpp v16, v12, v12 row_ror:8 row_mask:0xf bank_mask:0x3
v_add_f32_dpp v17, v14, v14 row_ror:8 row_mask:0xf bank_mask:0x3
s_nop 0
v_add_f32_dpp v16, v13, v13 row_ror:8 row_mask:0xf bank_mask:0xc
v_add_f32_dpp v17, v15, v15 row_ror:8 row_mask:0xf bank_mask:0xc
s_nop 0
v_add_f32_dpp v19, v16, v16 row_half_mirror row_mask:0xf bank_mask:0x5
s_nop 1
v_add_f32_dpp v19, v17, v17 row_half_mirror row_mask:0xf bank_mask:0xa
s_nop 1
v_add_f32_dpp v19, v19, v19 quad_perm:[1,0,3,2] row_mask:0xf bank_mask:0xf
s_nop 1
v_add_f32_dpp v19, v19, v19 quad_perm:[2,3,0,1] row_mask:0xf bank_mask:0xf
s_waitcnt vmcnt(5)
s_cmp_ge_u32 s3, 6
s_cbranch_scc1 L49
s_waitcnt vmcnt(4)
L49:
buffer_load_dwordx4 v[120:123], v2, s[40:43], s82 offen nt
s_add_u32 s82, s82, 4096
v_dot2_f32_bf16 v12, v96, v8, 0
v_dot2_f32_bf16 v12, v97, v9, v12
v_dot2_f32_bf16 v12, v98, v10, v12
v_dot2_f32_bf16 v12, v99, v11, v12
s_waitcnt vmcnt(5)
s_cmp_ge_u32 s3, 6
s_cbranch_scc1 L50
s_waitcnt vmcnt(4)
L50:
buffer_load_dwordx4 v[124:127], v2, s[40:43], s82 offen nt
s_add_u32 s82, s82, 4096
v_dot2_f32_bf16 v13, v100, v8, 0
v_dot2_f32_bf16 v13, v101, v9, v13
v_dot2_f32_bf16 v13, v102, v10, v13
v_dot2_f32_bf16 v13, v103, v11, v13
s_waitcnt vmcnt(5)
s_cmp_ge_u32 s3, 6
s_cbranch_scc1 L51
s_waitcnt vmcnt(4)
L51:
buffer_load_dwordx4 v[128:131], v2, s[40:43], s82 offen nt
s_add_u32 s82, s82, 4096
v_dot2_f32_bf16 v14, v104, v8, 0
v_dot2_f32_bf16 v14, v105, v9, v14
v_dot2_f32_bf16 v14, v106, v10, v14
v_dot2_f32_bf16 v14, v107, v11, v14
s_waitcnt vmcnt(5)
s_cmp_ge_u32 s3, 6
s_cbranch_scc1 L52
s_waitcnt vmcnt(4)
L52:
buffer_load_dwordx4 v[132:135], v2, s[40:43], s82 offen nt
s_add_u32 s82, s82, 4096
v_dot2_f32_bf16 v15, v108, v8, 0
v_dot2_f32_bf16 v15, v109, v9, v15
v_dot2_f32_bf16 v15, v110, v10, v15
v_dot2_f32_bf16 v15, v111, v11, v15
v_add_f32_dpp v16, v12, v12 row_ror:8 row_mask:0xf bank_mask:0x3
v_add_f32_dpp v17, v14, v14 row_ror:8 row_mask:0xf bank_mask:0x3
s_nop 0
v_add_f32_dpp v16, v13, v13 row_ror:8 row_mask:0xf bank_mask:0xc
v_add_f32_dpp v17, v15, v15 row_ror:8 row_mask:0xf bank_mask:0xc
s_nop 0
v_add_f32_dpp v20, v16, v16 row_half_mirror row_mask:0xf bank_mask:0x5
s_nop 1
v_add_f32_dpp v20, v17, v17 row_half_mirror row_mask:0xf bank_mask:0xa
s_nop 1
v_add_f32_dpp v20, v20, v20 quad_perm:[1,0,3,2] row_mask:0xf bank_mask:0xf
s_nop 1
v_add_f32_dpp v20, v20, v20 quad_perm:[2,3,0,1] row_mask:0xf bank_mask:0xf
s_waitcnt vmcnt(5)
s_cmp_ge_u32 s3, 6
s_cbranch_scc1 L53
s_waitcnt vmcnt(4)
L53:
buffer_load_dwordx4 v[136:139], v2, s[40:43], s82 offen nt
s_add_u32 s82, s82, 4096
v_dot2_f32_bf16 v12, v112, v8, 0
v_dot2_f32_bf16 v12, v113, v9, v12
v_dot2_f32_bf16 v12, v114, v10, v12
v_dot2_f32_bf16 v12, v115, v11, v12
s_waitcnt vmcnt(5)
s_cmp_ge_u32 s3, 6
s_cbranch_scc1 L54
s_waitcnt vmcnt(4)
L54:
buffer_load_dwordx4 v[140:143], v2, s[40:43], s82 offen nt
s_add_u32 s82, s82, 4096
v_dot2_f32_bf16 v13, v116, v8, 0
v_dot2_f32_bf16 v13, v117, v9, v13
v_dot2_f32_bf16 v13, v118, v10, v13
v_dot2_f32_bf16 v13, v119, v11, v13
s_waitcnt vmcnt(5)
s_cmp_ge_u32 s3, 6
s_cbranch_scc1 L55
s_waitcnt vmcnt(4)
L55:
buffer_load_dwordx4 v[144:147], v2, s[40:43], s82 offen nt
s_add_u32 s82, s82, 4096
v_dot2_f32_bf16 v14, v120, v8, 0
v_dot2_f32_bf16 v14, v121, v9, v14
v_dot2_f32_bf16 v14, v122, v10, v14
v_dot2_f32_bf16 v14, v123, v11, v14
s_waitcnt vmcnt(5)
s_cmp_ge_u32 s3, 6
s_cbranch_scc1 L56
s_waitcnt vmcnt(4)
L56:
buffer_load_dwordx4 v[148:151], v2, s[40:43], s82 offen nt
s_add_u32 s82, s82, 4096
v_dot2_f32_bf16 v15, v124, v8, 0
v_dot2_f32_bf16 v15, v125, v9, v15
v_dot2_f32_bf16 v15, v126, v10, v15
v_dot2_f32_bf16 v15, v127, v11, v15
v_add_f32_dpp v16, v12, v12 row_ror:8 row_mask:0xf bank_mask:0x3
v_add_f32_dpp v17, v14, v14 row_ror:8 row_mask:0xf bank_mask:0x3
s_nop 0
v_add_f32_dpp v16, v13, v13 row_ror:8 row_mask:0xf bank_mask:0xc
v_add_f32_dpp v17, v15, v15 row_ror:8 row_mask:0xf bank_mask:0xc
s_nop 0
v_add_f32_dpp v21, v16, v16 row_half_mirror row_mask:0xf bank_mask:0x5
s_nop 1
v_add_f32_dpp v21, v17, v17 row_half_mirror row_mask:0xf bank_mask:0xa
s_nop 1
v_add_f32_dpp v21, v21, v21 quad_perm:[1,0,3,2] row_mask:0xf bank_mask:0xf
s_nop 1
v_add_f32_dpp v21, v21, v21 quad_perm:[2,3,0,1] row_mask:0xf bank_mask:0xf
v_cndmask_b32 v22, v18, v19, s[88:89]
v_cndmask_b32 v22, v22, v20, s[90:91]
v_cndmask_b32 v22, v22, v21, s[92:93]
v_cvt_pk_bf16_f32 v22, v22, v22
v_lshlrev_b32 v22, 16, v22
v_mul_f32 v22, 0x3db504f3, v22
v_cvt_pk_bf16_f32 v22, v22, v22
v_lshlrev_b32 v22, 16, v22
ds_write_b32 v25, v22
v_max_f32 v24, v24, v22
v_add_u32 v25, 256, v25
v_add_u32 v202, 1, v202
s_cmp_eq_u32 s75, 0
s_cbranch_scc0 L57
ds_write_b32 v203, v202
L57:
s_waitcnt lgkmcnt(0)
v_readfirstlane_b32 s3, v200
ds_read_b32 v200, v201
s_waitcnt vmcnt(5)
s_cmp_ge_u32 s3, 6
s_cbranch_scc1 L58
s_waitcnt vmcnt(4)
L58:
buffer_load_dwordx4 v[152:155], v2, s[40:43], s82 offen nt
s_add_u32 s82, s82, 4096
v_dot2_f32_bf16 v12, v128, v8, 0
v_dot2_f32_bf16 v12, v129, v9, v12
v_dot2_f32_bf16 v12, v130, v10, v12
v_dot2_f32_bf16 v12, v131, v11, v12
s_waitcnt vmcnt(5)
s_cmp_ge_u32 s3, 6
s_cbranch_scc1 L59
s_waitcnt vmcnt(4)
L59:
buffer_load_dwordx4 v[156:159], v2, s[40:43], s82 offen nt
s_add_u32 s82, s82, 4096
v_dot2_f32_bf16 v13, v132, v8, 0
v_dot2_f32_bf16 v13, v133, v9, v13
v_dot2_f32_bf16 v13, v134, v10, v13
v_dot2_f32_bf16 v13, v135, v11, v13
s_waitcnt vmcnt(5)
s_cmp_ge_u32 s3, 6
s_cbranch_scc1 L60
s_waitcnt vmcnt(4)
L60:
buffer_load_dwordx4 v[160:163], v2, s[40:43], s82 offen nt
s_add_u32 s82, s82, 4096
v_dot2_f32_bf16 v14, v136, v8, 0
v_dot2_f32_bf16 v14, v137, v9, v14
v_dot2_f32_bf16 v14, v138, v10, v14
v_dot2_f32_bf16 v14, v139, v11, v14
s_waitcnt vmcnt(5)
s_cmp_ge_u32 s3, 6
s_cbranch_scc1 L61
s_waitcnt vmcnt(4)
L61:
buffer_load_dwordx4 v[164:167], v2, s[40:43], s82 offen nt
s_add_u32 s82, s82, 4096
v_dot2_f32_bf16 v15, v140, v8, 0
v_dot2_f32_bf16 v15, v141, v9, v15
v_dot2_f32_bf16 v15, v142, v10, v15
v_dot2_f32_bf16 v15, v143, v11, v15
v_add_f32_dpp v16, v12, v12 row_ror:8 row_mask:0xf bank_mask:0x3
v_add_f32_dpp v17, v14, v14 row_ror:8 row_mask:0xf bank_mask:0x3
s_nop 0
v_add_f32_dpp v16, v13, v13 row_ror:8 row_mask:0xf bank_mask:0xc
v_add_f32_dpp v17, v15, v15 row_ror:8 row_mask:0xf bank_mask:0xc
s_nop 0
v_add_f32_dpp v18, v16, v16 row_half_mirror row_mask:0xf bank_mask:0x5
s_nop 1
v_add_f32_dpp v18, v17, v17 row_half_mirror row_mask:0xf bank_mask:0xa
s_nop 1
v_add_f32_dpp v18, v18, v18 quad_perm:[1,0,3,2] row_mask:0xf bank_mask:0xf
s_nop 1
v_add_f32_dpp v18, v18, v18 quad_perm:[2,3,0,1] row_mask:0xf bank_mask:0xf
s_waitcnt vmcnt(5)
s_cmp_ge_u32 s3, 6
s_cbranch_scc1 L62
s_waitcnt vmcnt(4)
L62:
buffer_load_dwordx4 v[168:171], v2, s[40:43], s82 offen nt
s_add_u32 s82, s82, 4096
v_dot2_f32_bf16 v12, v144, v8, 0
v_dot2_f32_bf16 v12, v145, v9, v12
v_dot2_f32_bf16 v12, v146, v10, v12
v_dot2_f32_bf16 v12, v147, v11, v12
s_waitcnt vmcnt(5)
s_cmp_ge_u32 s3, 6
s_cbranch_scc1 L63
s_waitcnt vmcnt(4)
L63:
buffer_load_dwordx4 v[172:175], v2, s[40:43], s82 offen nt
s_add_u32 s82, s82, 4096
v_dot2_f32_bf16 v13, v148, v8, 0
v_dot2_f32_bf16 v13, v149, v9, v13
v_dot2_f32_bf16 v13, v150, v10, v13
v_dot2_f32_bf16 v13, v151, v11, v13
s_waitcnt vmcnt(5)
s_cmp_ge_u32 s3, 6
s_cbranch_scc1 L64
s_waitcnt vmcnt(4)
L64:
buffer_load_dwordx4 v[176:179], v2, s[40:43], s82 offen nt
s_add_u32 s82, s82, 4096
v_dot2_f32_bf16 v14, v152, v8, 0
v_dot2_f32_bf16 v14, v153, v9, v14
v_dot2_f32_bf16 v14, v154, v10, v14
v_dot2_f32_bf16 v14, v155, v11, v14
s_waitcnt vmcnt(5)
s_cmp_ge_u32 s3, 6
s_cbranch_scc1 L65
s_waitcnt vmcnt(4)
L65:
buffer_load_dwordx4 v[180:183], v2, s[40:43], s82 offen nt
s_add_u32 s82, s82, 4096
v_dot2_f32_bf16 v15, v156, v8, 0
v_dot2_f32_bf16 v15, v157, v9, v15
v_dot2_f32_bf16 v15, v158, v10, v15
v_dot2_f32_bf16 v15, v159, v11, v15
v_add_f32_dpp v16, v12, v12 row_ror:8 row_mask:0xf bank_mask:0x3
v_add_f32_dpp v17, v14, v14 row_ror:8 row_mask:0xf bank_mask:0x3
s_nop 0
v_add_f32_dpp v16, v13, v13 row_ror:8 row_mask:0xf bank_mask:0xc
v_add_f32_dpp v17, v15, v15 row_ror:8 row_mask:0xf bank_mask:0xc
s_nop 0
v_add_f32_dpp v19, v16, v16 row_half_mirror row_mask:0xf bank_mask:0x5
s_nop 1
v_add_f32_dpp v19, v17, v17 row_half_mirror row_mask:0xf bank_mask:0xa
s_nop 1
v_add_f32_dpp v19, v19, v19 quad_perm:[1,0,3,2] row_mask:0xf bank_mask:0xf
s_nop 1
v_add_f32_dpp v19, v19, v19 quad_perm:[2,3,0,1] row_mask:0xf bank_mask:0xf
s_waitcnt vmcnt(5)
s_cmp_ge_u32 s3, 6
s_cbranch_scc1 L66
s_waitcnt vmcnt(4)
L66:
buffer_load_dwordx4 v[184:187], v2, s[40:43], s82 offen nt
s_add_u32 s82, s82, 4096
v_dot2_f32_bf16 v12, v160, v8, 0
v_dot2_f32_bf16 v12, v161, v9, v12
v_dot2_f32_bf16 v12, v162, v10, v12
v_dot2_f32_bf16 v12, v163, v11, v12
s_waitcnt vmcnt(5)
s_cmp_ge_u32 s3, 6
s_cbranch_scc1 L67
s_waitcnt vmcnt(4)
L67:
buffer_load_dwordx4 v[188:191], v2, s[40:43], s82 offen nt
s_add_u32 s82, s82, 4096
v_dot2_f32_bf16 v13, v164, v8, 0
v_dot2_f32_bf16 v13, v165, v9, v13
v_dot2_f32_bf16 v13, v166, v10, v13
v_dot2_f32_bf16 v13, v167, v11, v13
s_waitcnt vmcnt(5)
s_cmp_ge_u32 s3, 6
s_cbranch_scc1 L68
s_waitcnt vmcnt(4)
L68:
buffer_load_dwordx4 v[64:67], v2, s[40:43], s82 offen nt
s_add_u32 s82, s82, 4096
v_dot2_f32_bf16 v14, v168, v8, 0
v_dot2_f32_bf16 v14, v169, v9, v14
v_dot2_f32_bf16 v14, v170, v10, v14
v_dot2_f32_bf16 v14, v171, v11, v14
s_waitcnt vmcnt(5)
s_cmp_ge_u32 s3, 6
s_cbranch_scc1 L69
s_waitcnt vmcnt(4)
L69:
buffer_load_dwordx4 v[68:71], v2, s[40:43], s82 offen nt
s_add_u32 s82, s82, 4096
v_dot2_f32_bf16 v15, v172, v8, 0
v_dot2_f32_bf16 v15, v173, v9, v15
v_dot2_f32_bf16 v15, v174, v10, v15
v_dot2_f32_bf16 v15, v175, v11, v15
v_add_f32_dpp v16, v12, v12 row_ror:8 row_mask:0xf bank_mask:0x3
v_add_f32_dpp v17, v14, v14 row_ror:8 row_mask:0xf bank_mask:0x3
s_nop 0
v_add_f32_dpp v16, v13, v13 row_ror:8 row_mask:0xf bank_mask:0xc
v_add_f32_dpp v17, v15, v15 row_ror:8 row_mask:0xf bank_mask:0xc
s_nop 0
v_add_f32_dpp v20, v16, v16 row_half_mirror row_mask:0xf bank_mask:0x5
s_nop 1
v_add_f32_dpp v20, v17, v17 row_half_mirror row_mask:0xf bank_mask:0xa
s_nop 1
v_add_f32_dpp v20, v20, v20 quad_perm:[1,0,3,2] row_mask:0xf bank_mask:0xf
s_nop 1
v_add_f32_dpp v20, v20, v20 quad_perm:[2,3,0,1] row_mask:0xf bank_mask:0xf
s_waitcnt vmcnt(5)
s_cmp_ge_u32 s3, 6
s_cbranch_scc1 L70
s_waitcnt vmcnt(4)
L70:
buffer_load_dwordx4 v[72:75], v2, s[40:43], s82 offen nt
s_add_u32 s82, s82, 4096
v_dot2_f32_bf16 v12, v176, v8, 0
v_dot2_f32_bf16 v12, v177, v9, v12
v_dot2_f32_bf16 v12, v178, v10, v12
v_dot2_f32_bf16 v12, v179, v11, v12
s_waitcnt vmcnt(5)
s_cmp_ge_u32 s3, 6
s_cbranch_scc1 L71
s_waitcnt vmcnt(4)
L71:
buffer_load_dwordx4 v[76:79], v2, s[40:43], s82 offen nt
s_add_u32 s82, s82, 4096
v_dot2_f32_bf16 v13, v180, v8, 0
v_dot2_f32_bf16 v13, v181, v9, v13
v_dot2_f32_bf16 v13, v182, v10, v13
v_dot2_f32_bf16 v13, v183, v11, v13
s_waitcnt vmcnt(5)
s_cmp_ge_u32 s3, 6
s_cbranch_scc1 L72
s_waitcnt vmcnt(4)
L72:
buffer_load_dwordx4 v[80:83], v2, s[40:43], s82 offen nt
s_add_u32 s82, s82, 4096
v_dot2_f32_bf16 v14, v184, v8, 0
v_dot2_f32_bf16 v14, v185, v9, v14
v_dot2_f32_bf16 v14, v186, v10, v14
v_dot2_f32_bf16 v14, v187, v11, v14
s_waitcnt vmcnt(5)
s_cmp_ge_u32 s3, 6
s_cbranch_scc1 L73
s_waitcnt vmcnt(4)
L73:
buffer_load_dwordx4 v[84:87], v2, s[40:43], s82 offen nt
s_add_u32 s82, s82, 4096
v_dot2_f32_bf16 v15, v188, v8, 0
v_dot2_f32_bf16 v15, v189, v9, v15
v_dot2_f32_bf16 v15, v190, v10, v15
v_dot2_f32_bf16 v15, v191, v11, v15
v_add_f32_dpp v16, v12, v12 row_ror:8 row_mask:0xf bank_mask:0x3
v_add_f32_dpp v17, v14, v14 row_ror:8 row_mask:0xf bank_mask:0x3
s_nop 0
v_add_f32_dpp v16, v13, v13 row_ror:8 row_mask:0xf bank_mask:0xc
v_add_f32_dpp v17, v15, v15 row_ror:8 row_mask:0xf bank_mask:0xc
s_nop 0
v_add_f32_dpp v21, v16, v16 row_half_mirror row_mask:0xf bank_mask:0x5
s_nop 1
v_add_f32_dpp v21, v17, v17 row_half_mirror row_mask:0xf bank_mask:0xa
s_nop 1
v_add_f32_dpp v21, v21, v21 quad_perm:[1,0,3,2] row_mask:0xf bank_mask:0xf
s_nop 1
v_add_f32_dpp v21, v21, v21 quad_perm:[2,3,0,1] row_mask:0xf bank_mask:0xf
v_cndmask_b32 v22, v18, v19, s[88:89]
v_cndmask_b32 v22, v22, v20, s[90:91]
v_cndmask_b32 v22, v22, v21, s[92:93]
v_cvt_pk_bf16_f32 v22, v22, v22
v_lshlrev_b32 v22, 16, v22
v_mul_f32 v22, 0x3db504f3, v22
v_cvt_pk_bf16_f32 v22, v22, v22
v_lshlrev_b32 v22, 16, v22
ds_write_b32 v25, v22
v_max_f32 v24, v24, v22
v_add_u32 v25, 256, v25
v_add_u32 v202, 1, v202
s_cmp_eq_u32 s75, 0
s_cbranch_scc0 L74
ds_write_b32 v203, v202
L74:
s_add_u32 s79, s79, 1
s_cmp_lt_u32 s79, 6
s_cbranch_scc1 L40
s_waitcnt lgkmcnt(0)
v_readfirstlane_b32 s3, v200
ds_read_b32 v200, v201
s_waitcnt vmcnt(5)
s_cmp_ge_u32 s3, 6
s_cbranch_scc1 L75
s_waitcnt vmcnt(4)
L75:
buffer_load_dwordx4 v[88:91], v2, s[40:43], s82 offen nt
s_add_u32 s82, s82, 4096
v_dot2_f32_bf16 v12, v64, v8, 0
v_dot2_f32_bf16 v12, v65, v9, v12
v_dot2_f32_bf16 v12, v66, v10, v12
v_dot2_f32_bf16 v12, v67, v11, v12
s_waitcnt vmcnt(5)
s_cmp_ge_u32 s3, 6
s_cbranch_scc1 L76
s_waitcnt vmcnt(4)
L76:
buffer_load_dwordx4 v[92:95], v2, s[40:43], s82 offen nt
s_add_u32 s82, s82, 4096
v_dot2_f32_bf16 v13, v68, v8, 0
v_dot2_f32_bf16 v13, v69, v9, v13
v_dot2_f32_bf16 v13, v70, v10, v13
v_dot2_f32_bf16 v13, v71, v11, v13
s_waitcnt vmcnt(5)
s_cmp_ge_u32 s3, 6
s_cbranch_scc1 L77
s_waitcnt vmcnt(4)
L77:
buffer_load_dwordx4 v[96:99], v2, s[40:43], s82 offen nt
s_add_u32 s82, s82, 4096
v_dot2_f32_bf16 v14, v72, v8, 0
v_dot2_f32_bf16 v14, v73, v9, v14
v_dot2_f32_bf16 v14, v74, v10, v14
v_dot2_f32_bf16 v14, v75, v11, v14
s_waitcnt vmcnt(5)
s_cmp_ge_u32 s3, 6
s_cbranch_scc1 L78
s_waitcnt vmcnt(4)
L78:
buffer_load_dwordx4 v[100:103], v2, s[40:43], s82 offen nt
s_add_u32 s82, s82, 4096
v_dot2_f32_bf16 v15, v76, v8, 0
v_dot2_f32_bf16 v15, v77, v9, v15
v_dot2_f32_bf16 v15, v78, v10, v15
v_dot2_f32_bf16 v15, v79, v11, v15
v_add_f32_dpp v16, v12, v12 row_ror:8 row_mask:0xf bank_mask:0x3
v_add_f32_dpp v17, v14, v14 row_ror:8 row_mask:0xf bank_mask:0x3
s_nop 0
v_add_f32_dpp v16, v13, v13 row_ror:8 row_mask:0xf bank_mask:0xc
v_add_f32_dpp v17, v15, v15 row_ror:8 row_mask:0xf bank_mask:0xc
s_nop 0
v_add_f32_dpp v18, v16, v16 row_half_mirror row_mask:0xf bank_mask:0x5
s_nop 1
v_add_f32_dpp v18, v17, v17 row_half_mirror row_mask:0xf bank_mask:0xa
s_nop 1
v_add_f32_dpp v18, v18, v18 quad_perm:[1,0,3,2] row_mask:0xf bank_mask:0xf
s_nop 1
v_add_f32_dpp v18, v18, v18 quad_perm:[2,3,0,1] row_mask:0xf bank_mask:0xf
s_waitcnt vmcnt(5)
s_cmp_ge_u32 s3, 6
s_cbranch_scc1 L79
s_waitcnt vmcnt(4)
L79:
buffer_load_dwordx4 v[104:107], v2, s[40:43], s82 offen nt
s_add_u32 s82, s82, 4096
v_dot2_f32_bf16 v12, v80, v8, 0
v_dot2_f32_bf16 v12, v81, v9, v12
v_dot2_f32_bf16 v12, v82, v10, v12
v_dot2_f32_bf16 v12, v83, v11, v12
s_waitcnt vmcnt(5)
s_cmp_ge_u32 s3, 6
s_cbranch_scc1 L80
s_waitcnt vmcnt(4)
L80:
buffer_load_dwordx4 v[108:111], v2, s[40:43], s82 offen nt
s_add_u32 s82, s82, 4096
v_dot2_f32_bf16 v13, v84, v8, 0
v_dot2_f32_bf16 v13, v85, v9, v13
v_dot2_f32_bf16 v13, v86, v10, v13
v_dot2_f32_bf16 v13, v87, v11, v13
s_waitcnt vmcnt(5)
s_cmp_ge_u32 s3, 6
s_cbranch_scc1 L81
s_waitcnt vmcnt(4)
L81:
buffer_load_dwordx4 v[112:115], v2, s[40:43], s82 offen nt
s_add_u32 s82, s82, 4096
v_dot2_f32_bf16 v14, v88, v8, 0
v_dot2_f32_bf16 v14, v89, v9, v14
v_dot2_f32_bf16 v14, v90, v10, v14
v_dot2_f32_bf16 v14, v91, v11, v14
s_waitcnt vmcnt(5)
s_cmp_ge_u32 s3, 6
s_cbranch_scc1 L82
s_waitcnt vmcnt(4)
L82:
buffer_load_dwordx4 v[116:119], v2, s[40:43], s82 offen nt
s_add_u32 s82, s82, 4096
v_dot2_f32_bf16 v15, v92, v8, 0
v_dot2_f32_bf16 v15, v93, v9, v15
v_dot2_f32_bf16 v15, v94, v10, v15
v_dot2_f32_bf16 v15, v95, v11, v15
v_add_f32_dpp v16, v12, v12 row_ror:8 row_mask:0xf bank_mask:0x3
v_add_f32_dpp v17, v14, v14 row_ror:8 row_mask:0xf bank_mask:0x3
s_nop 0
v_add_f32_dpp v16, v13, v13 row_ror:8 row_mask:0xf bank_mask:0xc
v_add_f32_dpp v17, v15, v15 row_ror:8 row_mask:0xf bank_mask:0xc
s_nop 0
v_add_f32_dpp v19, v16, v16 row_half_mirror row_mask:0xf bank_mask:0x5
s_nop 1
v_add_f32_dpp v19, v17, v17 row_half_mirror row_mask:0xf bank_mask:0xa
s_nop 1
v_add_f32_dpp v19, v19, v19 quad_perm:[1,0,3,2] row_mask:0xf bank_mask:0xf
s_nop 1
v_add_f32_dpp v19, v19, v19 quad_perm:[2,3,0,1] row_mask:0xf bank_mask:0xf
s_waitcnt vmcnt(5)
s_cmp_ge_u32 s3, 6
s_cbranch_scc1 L83
s_waitcnt vmcnt(4)
L83:
buffer_load_dwordx4 v[120:123], v2, s[40:43], s82 offen nt
s_add_u32 s82, s82, 4096
v_dot2_f32_bf16 v12, v96, v8, 0
v_dot2_f32_bf16 v12, v97, v9, v12
v_dot2_f32_bf16 v12, v98, v10, v12
v_dot2_f32_bf16 v12, v99, v11, v12
s_waitcnt vmcnt(5)
s_cmp_ge_u32 s3, 6
s_cbranch_scc1 L84
s_waitcnt vmcnt(4)
L84:
buffer_load_dwordx4 v[124:127], v2, s[40:43], s82 offen nt
s_add_u32 s82, s82, 4096
v_dot2_f32_bf16 v13, v100, v8, 0
v_dot2_f32_bf16 v13, v101, v9, v13
v_dot2_f32_bf16 v13, v102, v10, v13
v_dot2_f32_bf16 v13, v103, v11, v13
s_waitcnt vmcnt(5)
s_cmp_ge_u32 s3, 6
s_cbranch_scc1 L85
s_waitcnt vmcnt(4)
L85:
buffer_load_dwordx4 v[128:131], v2, s[40:43], s82 offen nt
s_add_u32 s82, s82, 4096
v_dot2_f32_bf16 v14, v104, v8, 0
v_dot2_f32_bf16 v14, v105, v9, v14
v_dot2_f32_bf16 v14, v106, v10, v14
v_dot2_f32_bf16 v14, v107, v11, v14
s_waitcnt vmcnt(5)
s_cmp_ge_u32 s3, 6
s_cbranch_scc1 L86
s_waitcnt vmcnt(4)
L86:
buffer_load_dwordx4 v[132:135], v2, s[40:43], s82 offen nt
s_add_u32 s82, s82, 4096
v_dot2_f32_bf16 v15, v108, v8, 0
v_dot2_f32_bf16 v15, v109, v9, v15
v_dot2_f32_bf16 v15, v110, v10, v15
v_dot2_f32_bf16 v15, v111, v11, v15
v_add_f32_dpp v16, v12, v12 row_ror:8 row_mask:0xf bank_mask:0x3
v_add_f32_dpp v17, v14, v14 row_ror:8 row_mask:0xf bank_mask:0x3
s_nop 0
v_add_f32_dpp v16, v13, v13 row_ror:8 row_mask:0xf bank_mask:0xc
v_add_f32_dpp v17, v15, v15 row_ror:8 row_mask:0xf bank_mask:0xc
s_nop 0
v_add_f32_dpp v20, v16, v16 row_half_mirror row_mask:0xf bank_mask:0x5
s_nop 1
v_add_f32_dpp v20, v17, v17 row_half_mirror row_mask:0xf bank_mask:0xa
s_nop 1
v_add_f32_dpp v20, v20, v20 quad_perm:[1,0,3,2] row_mask:0xf bank_mask:0xf
s_nop 1
v_add_f32_dpp v20, v20, v20 quad_perm:[2,3,0,1] row_mask:0xf bank_mask:0xf
s_waitcnt vmcnt(5)
s_cmp_ge_u32 s3, 6
s_cbranch_scc1 L87
s_waitcnt vmcnt(4)
L87:
buffer_load_dwordx4 v[136:139], v2, s[40:43], s82 offen nt
s_add_u32 s82, s82, 4096
v_dot2_f32_bf16 v12, v112, v8, 0
v_dot2_f32_bf16 v12, v113, v9, v12
v_dot2_f32_bf16 v12, v114, v10, v12
v_dot2_f32_bf16 v12, v115, v11, v12
s_waitcnt vmcnt(5)
s_cmp_ge_u32 s3, 6
s_cbranch_scc1 L88
s_waitcnt vmcnt(4)
L88:
buffer_load_dwordx4 v[140:143], v2, s[40:43], s82 offen nt
s_add_u32 s82, s82, 4096
v_dot2_f32_bf16 v13, v116, v8, 0
v_dot2_f32_bf16 v13, v117, v9, v13
v_dot2_f32_bf16 v13, v118, v10, v13
v_dot2_f32_bf16 v13, v119, v11, v13
s_waitcnt vmcnt(5)
s_cmp_ge_u32 s3, 6
s_cbranch_scc1 L89
s_waitcnt vmcnt(4)
L89:
buffer_load_dwordx4 v[144:147], v2, s[40:43], s82 offen nt
s_add_u32 s82, s82, 4096
v_dot2_f32_bf16 v14, v120, v8, 0
v_dot2_f32_bf16 v14, v121, v9, v14
v_dot2_f32_bf16 v14, v122, v10, v14
v_dot2_f32_bf16 v14, v123, v11, v14
s_waitcnt vmcnt(5)
s_cmp_ge_u32 s3, 6
s_cbranch_scc1 L90
s_waitcnt vmcnt(4)
L90:
buffer_load_dwordx4 v[148:151], v2, s[40:43], s82 offen nt
s_add_u32 s82, s82, 4096
v_dot2_f32_bf16 v15, v124, v8, 0
v_dot2_f32_bf16 v15, v125, v9, v15
v_dot2_f32_bf16 v15, v126, v10, v15
v_dot2_f32_bf16 v15, v127, v11, v15
v_add_f32_dpp v16, v12, v12 row_ror:8 row_mask:0xf bank_mask:0x3
v_add_f32_dpp v17, v14, v14 row_ror:8 row_mask:0xf bank_mask:0x3
s_nop 0
v_add_f32_dpp v16, v13, v13 row_ror:8 row_mask:0xf bank_mask:0xc
v_add_f32_dpp v17, v15, v15 row_ror:8 row_mask:0xf bank_mask:0xc
s_nop 0
v_add_f32_dpp v21, v16, v16 row_half_mirror row_mask:0xf bank_mask:0x5
s_nop 1
v_add_f32_dpp v21, v17, v17 row_half_mirror row_mask:0xf bank_mask:0xa
s_nop 1
v_add_f32_dpp v21, v21, v21 quad_perm:[1,0,3,2] row_mask:0xf bank_mask:0xf
s_nop 1
v_add_f32_dpp v21, v21, v21 quad_perm:[2,3,0,1] row_mask:0xf bank_mask:0xf
v_cndmask_b32 v22, v18, v19, s[88:89]
v_cndmask_b32 v22, v22, v20, s[90:91]
v_cndmask_b32 v22, v22, v21, s[92:93]
v_cvt_pk_bf16_f32 v22, v22, v22
v_lshlrev_b32 v22, 16, v22
v_mul_f32 v22, 0x3db504f3, v22
v_cvt_pk_bf16_f32 v22, v22, v22
v_lshlrev_b32 v22, 16, v22
ds_write_b32 v25, v22
v_max_f32 v24, v24, v22
v_add_u32 v25, 256, v25
v_add_u32 v202, 1, v202
s_cmp_eq_u32 s75, 0
s_cbranch_scc0 L91
ds_write_b32 v203, v202
L91:
s_waitcnt lgkmcnt(0)
v_readfirstlane_b32 s3, v200
ds_read_b32 v200, v201
s_waitcnt vmcnt(5)
s_cmp_ge_u32 s3, 6
s_cbranch_scc1 L92
s_waitcnt vmcnt(4)
L92:
buffer_load_dwordx4 v[152:155], v2, s[40:43], s82 offen nt
s_add_u32 s82, s82, 4096
v_dot2_f32_bf16 v12, v128, v8, 0
v_dot2_f32_bf16 v12, v129, v9, v12
v_dot2_f32_bf16 v12, v130, v10, v12
v_dot2_f32_bf16 v12, v131, v11, v12
s_waitcnt vmcnt(5)
s_cmp_ge_u32 s3, 6
s_cbranch_scc1 L93
s_waitcnt vmcnt(4)
L93:
buffer_load_dwordx4 v[156:159], v2, s[40:43], s82 offen nt
s_add_u32 s82, s82, 4096
v_dot2_f32_bf16 v13, v132, v8, 0
v_dot2_f32_bf16 v13, v133, v9, v13
v_dot2_f32_bf16 v13, v134, v10, v13
v_dot2_f32_bf16 v13, v135, v11, v13
s_waitcnt vmcnt(5)
s_cmp_ge_u32 s3, 6
s_cbranch_scc1 L94
s_waitcnt vmcnt(4)
L94:
buffer_load_dwordx4 v[160:163], v2, s[40:43], s82 offen nt
s_add_u32 s82, s82, 4096
v_dot2_f32_bf16 v14, v136, v8, 0
v_dot2_f32_bf16 v14, v137, v9, v14
v_dot2_f32_bf16 v14, v138, v10, v14
v_dot2_f32_bf16 v14, v139, v11, v14
s_waitcnt vmcnt(5)
s_cmp_ge_u32 s3, 6
s_cbranch_scc1 L95
s_waitcnt vmcnt(4)
L95:
buffer_load_dwordx4 v[164:167], v2, s[40:43], s82 offen nt
s_add_u32 s82, s82, 4096
v_dot2_f32_bf16 v15, v140, v8, 0
v_dot2_f32_bf16 v15, v141, v9, v15
v_dot2_f32_bf16 v15, v142, v10, v15
v_dot2_f32_bf16 v15, v143, v11, v15
v_add_f32_dpp v16, v12, v12 row_ror:8 row_mask:0xf bank_mask:0x3
v_add_f32_dpp v17, v14, v14 row_ror:8 row_mask:0xf bank_mask:0x3
s_nop 0
v_add_f32_dpp v16, v13, v13 row_ror:8 row_mask:0xf bank_mask:0xc
v_add_f32_dpp v17, v15, v15 row_ror:8 row_mask:0xf bank_mask:0xc
s_nop 0
v_add_f32_dpp v18, v16, v16 row_half_mirror row_mask:0xf bank_mask:0x5
s_nop 1
v_add_f32_dpp v18, v17, v17 row_half_mirror row_mask:0xf bank_mask:0xa
s_nop 1
v_add_f32_dpp v18, v18, v18 quad_perm:[1,0,3,2] row_mask:0xf bank_mask:0xf
s_nop 1
v_add_f32_dpp v18, v18, v18 quad_perm:[2,3,0,1] row_mask:0xf bank_mask:0xf
s_waitcnt vmcnt(5)
s_cmp_ge_u32 s3, 6
s_cbranch_scc1 L96
s_waitcnt vmcnt(4)
L96:
buffer_load_dwordx4 v[168:171], v2, s[40:43], s82 offen nt
s_add_u32 s82, s82, 4096
v_dot2_f32_bf16 v12, v144, v8, 0
v_dot2_f32_bf16 v12, v145, v9, v12
v_dot2_f32_bf16 v12, v146, v10, v12
v_dot2_f32_bf16 v12, v147, v11, v12
s_waitcnt vmcnt(5)
s_cmp_ge_u32 s3, 6
s_cbranch_scc1 L97
s_waitcnt vmcnt(4)
L97:
buffer_load_dwordx4 v[172:175], v2, s[40:43], s82 offen nt
s_add_u32 s82, s82, 4096
v_dot2_f32_bf16 v13, v148, v8, 0
v_dot2_f32_bf16 v13, v149, v9, v13
v_dot2_f32_bf16 v13, v150, v10, v13
v_dot2_f32_bf16 v13, v151, v11, v13
s_waitcnt vmcnt(5)
s_cmp_ge_u32 s3, 6
s_cbranch_scc1 L98
s_waitcnt vmcnt(4)
L98:
buffer_load_dwordx4 v[176:179], v2, s[40:43], s82 offen nt
s_add_u32 s82, s82, 4096
v_dot2_f32_bf16 v14, v152, v8, 0
v_dot2_f32_bf16 v14, v153, v9, v14
v_dot2_f32_bf16 v14, v154, v10, v14
v_dot2_f32_bf16 v14, v155, v11, v14
s_waitcnt vmcnt(5)
s_cmp_ge_u32 s3, 6
s_cbranch_scc1 L99
s_waitcnt vmcnt(4)
L99:
buffer_load_dwordx4 v[180:183], v2, s[40:43], s82 offen nt
s_add_u32 s82, s82, 4096
v_dot2_f32_bf16 v15, v156, v8, 0
v_dot2_f32_bf16 v15, v157, v9, v15
v_dot2_f32_bf16 v15, v158, v10, v15
v_dot2_f32_bf16 v15, v159, v11, v15
v_add_f32_dpp v16, v12, v12 row_ror:8 row_mask:0xf bank_mask:0x3
v_add_f32_dpp v17, v14, v14 row_ror:8 row_mask:0xf bank_mask:0x3
s_nop 0
v_add_f32_dpp v16, v13, v13 row_ror:8 row_mask:0xf bank_mask:0xc
v_add_f32_dpp v17, v15, v15 row_ror:8 row_mask:0xf bank_mask:0xc
s_nop 0
v_add_f32_dpp v19, v16, v16 row_half_mirror row_mask:0xf bank_mask:0x5
s_nop 1
v_add_f32_dpp v19, v17, v17 row_half_mirror row_mask:0xf bank_mask:0xa
s_nop 1
v_add_f32_dpp v19, v19, v19 quad_perm:[1,0,3,2] row_mask:0xf bank_mask:0xf
s_nop 1
v_add_f32_dpp v19, v19, v19 quad_perm:[2,3,0,1] row_mask:0xf bank_mask:0xf
s_waitcnt vmcnt(5)
s_cmp_ge_u32 s3, 6
s_cbranch_scc1 L100
s_waitcnt vmcnt(4)
L100:
buffer_load_dwordx4 v[184:187], v2, s[40:43], s82 offen nt
s_add_u32 s82, s82, 4096
v_dot2_f32_bf16 v12, v160, v8, 0
v_dot2_f32_bf16 v12, v161, v9, v12
v_dot2_f32_bf16 v12, v162, v10, v12
v_dot2_f32_bf16 v12, v163, v11, v12
s_waitcnt vmcnt(5)
s_cmp_ge_u32 s3, 6
s_cbranch_scc1 L101
s_waitcnt vmcnt(4)
L101:
buffer_load_dwordx4 v[188:191], v2, s[40:43], s82 offen nt
s_add_u32 s82, s82, 4096
v_dot2_f32_bf16 v13, v164, v8, 0
v_dot2_f32_bf16 v13, v165, v9, v13
v_dot2_f32_bf16 v13, v166, v10, v13
v_dot2_f32_bf16 v13, v167, v11, v13
s_waitcnt vmcnt(5)
s_cmp_ge_u32 s3, 6
s_cbranch_scc1 L102
s_waitcnt vmcnt(4)
L102:
s_mov_b32 s82, s50
buffer_load_dwordx4 v[64:67], v2, s[44:47], s82 offen nt
s_add_u32 s82, s82, 4096
v_dot2_f32_bf16 v14, v168, v8, 0
v_dot2_f32_bf16 v14, v169, v9, v14
v_dot2_f32_bf16 v14, v170, v10, v14
v_dot2_f32_bf16 v14, v171, v11, v14
s_waitcnt vmcnt(5)
s_cmp_ge_u32 s3, 6
s_cbranch_scc1 L103
s_waitcnt vmcnt(4)
L103:
buffer_load_dwordx4 v[68:71], v2, s[44:47], s82 offen nt
s_add_u32 s82, s82, 4096
v_dot2_f32_bf16 v15, v172, v8, 0
v_dot2_f32_bf16 v15, v173, v9, v15
v_dot2_f32_bf16 v15, v174, v10, v15
v_dot2_f32_bf16 v15, v175, v11, v15
v_add_f32_dpp v16, v12, v12 row_ror:8 row_mask:0xf bank_mask:0x3
v_add_f32_dpp v17, v14, v14 row_ror:8 row_mask:0xf bank_mask:0x3
s_nop 0
v_add_f32_dpp v16, v13, v13 row_ror:8 row_mask:0xf bank_mask:0xc
v_add_f32_dpp v17, v15, v15 row_ror:8 row_mask:0xf bank_mask:0xc
s_nop 0
v_add_f32_dpp v20, v16, v16 row_half_mirror row_mask:0xf bank_mask:0x5
s_nop 1
v_add_f32_dpp v20, v17, v17 row_half_mirror row_mask:0xf bank_mask:0xa
s_nop 1
v_add_f32_dpp v20, v20, v20 quad_perm:[1,0,3,2] row_mask:0xf bank_mask:0xf
s_nop 1
v_add_f32_dpp v20, v20, v20 quad_perm:[2,3,0,1] row_mask:0xf bank_mask:0xf
s_waitcnt vmcnt(5)
s_cmp_ge_u32 s3, 6
s_cbranch_scc1 L104
s_waitcnt vmcnt(4)
L104:
buffer_load_dwordx4 v[72:75], v2, s[44:47], s82 offen nt
s_add_u32 s82, s82, 4096
v_dot2_f32_bf16 v12, v176, v8, 0
v_dot2_f32_bf16 v12, v177, v9, v12
v_dot2_f32_bf16 v12, v178, v10, v12
v_dot2_f32_bf16 v12, v179, v11, v12
s_waitcnt vmcnt(5)
s_cmp_ge_u32 s3, 6
s_cbranch_scc1 L105
s_waitcnt vmcnt(4)
L105:
buffer_load_dwordx4 v[76:79], v2, s[44:47], s82 offen nt
s_add_u32 s82, s82, 4096
v_dot2_f32_bf16 v13, v180, v8, 0
v_dot2_f32_bf16 v13, v181, v9, v13
v_dot2_f32_bf16 v13, v182, v10, v13
v_dot2_f32_bf16 v13, v183, v11, v13
s_waitcnt vmcnt(5)
s_cmp_ge_u32 s3, 6
s_cbranch_scc1 L106
s_waitcnt vmcnt(4)
L106:
buffer_load_dwordx4 v[80:83], v2, s[44:47], s82 offen nt
s_add_u32 s82, s82, 4096
v_dot2_f32_bf16 v14, v184, v8, 0
v_dot2_f32_bf16 v14, v185, v9, v14
v_dot2_f32_bf16 v14, v186, v10, v14
v_dot2_f32_bf16 v14, v187, v11, v14
s_waitcnt vmcnt(5)
s_cmp_ge_u32 s3, 6
s_cbranch_scc1 L107
s_waitcnt vmcnt(4)
L107:
buffer_load_dwordx4 v[84:87], v2, s[44:47], s82 offen nt
s_add_u32 s82, s82, 4096
v_dot2_f32_bf16 v15, v188, v8, 0
v_dot2_f32_bf16 v15, v189, v9, v15
v_dot2_f32_bf16 v15, v190, v10, v15
v_dot2_f32_bf16 v15, v191, v11, v15
v_add_f32_dpp v16, v12, v12 row_ror:8 row_mask:0xf bank_mask:0x3
v_add_f32_dpp v17, v14, v14 row_ror:8 row_mask:0xf bank_mask:0x3
s_nop 0
v_add_f32_dpp v16, v13, v13 row_ror:8 row_mask:0xf bank_mask:0xc
v_add_f32_dpp v17, v15, v15 row_ror:8 row_mask:0xf bank_mask:0xc
s_nop 0
v_add_f32_dpp v21, v16, v16 row_half_mirror row_mask:0xf bank_mask:0x5
s_nop 1
v_add_f32_dpp v21, v17, v17 row_half_mirror row_mask:0xf bank_mask:0xa
s_nop 1
v_add_f32_dpp v21, v21, v21 quad_perm:[1,0,3,2] row_mask:0xf bank_mask:0xf
s_nop 1
v_add_f32_dpp v21, v21, v21 quad_perm:[2,3,0,1] row_mask:0xf bank_mask:0xf
v_cndmask_b32 v22, v18, v19, s[88:89]
v_cndmask_b32 v22, v22, v20, s[90:91]
v_cndmask_b32 v22, v22, v21, s[92:93]
v_cvt_pk_bf16_f32 v22, v22, v22
v_lshlrev_b32 v22, 16, v22
v_mul_f32 v22, 0x3db504f3, v22
v_cvt_pk_bf16_f32 v22, v22, v22
v_lshlrev_b32 v22, 16, v22
ds_write_b32 v25, v22
v_max_f32 v24, v24, v22
v_add_u32 v25, 256, v25
v_add_u32 v202, 1, v202
s_cmp_eq_u32 s75, 0
s_cbranch_scc0 L108
ds_write_b32 v203, v202
L108:
buffer_load_dwordx4 v[88:91], v2, s[44:47], s82 offen nt
s_add_u32 s82, s82, 4096
buffer_load_dwordx4 v[92:95], v2, s[44:47], s82 offen nt
s_add_u32 s82, s82, 4096
buffer_load_dwordx4 v[96:99], v2, s[44:47], s82 offen nt
s_add_u32 s82, s82, 4096
buffer_load_dwordx4 v[100:103], v2, s[44:47], s82 offen nt
s_add_u32 s82, s82, 4096
buffer_load_dwordx4 v[104:107], v2, s[44:47], s82 offen nt
s_add_u32 s82, s82, 4096
buffer_load_dwordx4 v[108:111], v2, s[44:47], s82 offen nt
s_add_u32 s82, s82, 4096
buffer_load_dwordx4 v[112:115], v2, s[44:47], s82 offen nt
s_add_u32 s82, s82, 4096
buffer_load_dwordx4 v[116:119], v2, s[44:47], s82 offen nt
s_add_u32 s82, s82, 4096
buffer_load_dwordx4 v[120:123], v2, s[44:47], s82 offen nt
s_add_u32 s82, s82, 4096
buffer_load_dwordx4 v[124:127], v2, s[44:47], s82 offen nt
s_add_u32 s82, s82, 4096
v_max_f32_dpp v24, v24, v24 row_ror:8 row_mask:0xf bank_mask:0xf
s_nop 1
v_max_f32_dpp v24, v24, v24 row_ror:4 row_mask:0xf bank_mask:0xf
s_nop 1
v_max_f32_dpp v24, v24, v24 row_ror:2 row_mask:0xf bank_mask:0xf
s_nop 1
v_max_f32_dpp v24, v24, v24 row_ror:1 row_mask:0xf bank_mask:0xf
v_lshrrev_b32 v6, 4, v1
v_lshlrev_b32 v6, 2, v6
s_lshl_b32 s76, s75, 4
v_add_u32 v6, s76, v6
v_add_u32 v7, 150080, v6
ds_write_b32 v7, v24
s_lshl_b32 s76, s75, 12
s_add_u32 s76, s76, 131072
v_add_u32 v14, s76, v3
s_waitcnt lgkmcnt(0)
ds_read_b32 v48, v14 offset:0
ds_read_b32 v49, v14 offset:256
ds_read_b32 v50, v14 offset:512
ds_read_b32 v51, v14 offset:768
ds_read_b32 v52, v14 offset:1024
ds_read_b32 v53, v14 offset:1280
ds_read_b32 v54, v14 offset:1536
ds_read_b32 v55, v14 offset:1792
ds_read_b32 v56, v14 offset:2048
ds_read_b32 v57, v14 offset:2304
ds_read_b32 v58, v14 offset:2560
ds_read_b32 v59, v14 offset:2816
ds_read_b32 v60, v14 offset:3072
ds_read_b32 v61, v14 offset:3328
ds_read_b32 v62, v14 offset:3584
ds_read_b32 v63, v14 offset:3840
s_barrier
v_mov_b32 v7, 150080
ds_read_b128 v[32:35], v7
ds_read_b128 v[36:39], v7 offset:16
ds_read_b128 v[40:43], v7 offset:32
ds_read_b128 v[44:47], v7 offset:48
s_mov_b32 s77, 0x3fb8aa3b
s_waitcnt lgkmcnt(0)
v_max3_f32 v24, v32, v33, v34
v_max3_f32 v24, v24, v35, v36
v_max3_f32 v24, v24, v37, v38
v_max3_f32 v24, v24, v39, v40
v_max3_f32 v24, v24, v41, v42
v_max3_f32 v24, v24, v43, v44
v_max3_f32 v24, v24, v45, v46
v_max_f32 v24, v24, v47
v_sub_f32 v48, v48, v24
v_sub_f32 v49, v49, v24
v_sub_f32 v50, v50, v24
v_sub_f32 v51, v51, v24
v_sub_f32 v52, v52, v24
v_sub_f32 v53, v53, v24
v_sub_f32 v54, v54, v24
v_sub_f32 v55, v55, v24
v_sub_f32 v56, v56, v24
v_sub_f32 v57, v57, v24
v_sub_f32 v58, v58, v24
v_sub_f32 v59, v59, v24
v_sub_f32 v60, v60, v24
v_sub_f32 v61, v61, v24
v_sub_f32 v62, v62, v24
v_sub_f32 v63, v63, v24
v_mul_f32 v48, s77, v48
v_mul_f32 v49, s77, v49
v_mul_f32 v50, s77, v50
v_mul_f32 v51, s77, v51
v_mul_f32 v52, s77, v52
v_mul_f32 v53, s77, v53
v_mul_f32 v54, s77, v54
v_mul_f32 v55, s77, v55
v_mul_f32 v56, s77, v56
v_mul_f32 v57, s77, v57
v_mul_f32 v58, s77, v58
v_mul_f32 v59, s77, v59
v_mul_f32 v60, s77, v60
v_mul_f32 v61, s77, v61
v_mul_f32 v62, s77, v62
v_mul_f32 v63, s77, v63
v_exp_f32 v48, v48
v_exp_f32 v49, v49
v_exp_f32 v50, v50
v_exp_f32 v51, v51
v_exp_f32 v52, v52
v_exp_f32 v53, v53
v_exp_f32 v54, v54
v_exp_f32 v55, v55
v_exp_f32 v56, v56
v_exp_f32 v57, v57
v_exp_f32 v58, v58
v_exp_f32 v59, v59
v_exp_f32 v60, v60
v_exp_f32 v61, v61
v_exp_f32 v62, v62
v_exp_f32 v63, v63
v_add_f32 v23, v48, v49
v_add_f32 v23, v23, v50
v_add_f32 v23, v23, v51
v_add_f32 v23, v23, v52
v_add_f32 v23, v23, v53
v_add_f32 v23, v23, v54
v_add_f32 v23, v23, v55
v_add_f32 v23, v23, v56
v_add_f32 v23, v23, v57
v_add_f32 v23, v23, v58
v_add_f32 v23, v23, v59
v_add_f32 v23, v23, v60
v_add_f32 v23, v23, v61
v_add_f32 v23, v23, v62
v_add_f32 v23, v23, v63
s_nop 1
v_add_f32_dpp v23, v23, v23 row_ror:8 row_mask:0xf bank_mask:0xf
s_nop 1
v_add_f32_dpp v23, v23, v23 row_ror:4 row_mask:0xf bank_mask:0xf
s_nop 1
v_add_f32_dpp v23, v23, v23 row_ror:2 row_mask:0xf bank_mask:0xf
s_nop 1
v_add_f32_dpp v23, v23, v23 row_ror:1 row_mask:0xf bank_mask:0xf
v_add_u32 v7, 150144, v6
ds_write_b32 v7, v23
s_waitcnt lgkmcnt(0)
s_barrier
v_mov_b32 v7, 150144
ds_read_b128 v[32:35], v7
ds_read_b128 v[36:39], v7 offset:16
ds_read_b128 v[40:43], v7 offset:32
ds_read_b128 v[44:47], v7 offset:48
v_and_b32 v6, 15, v1
v_lshrrev_b32 v7, 1, v6
v_and_b32 v5, 1, v6
v_lshlrev_b32 v5, 4, v5
v_mov_b32 v4, 0xffff
v_lshlrev_b32 v4, v5, v4
v_cmp_eq_u32 vcc, 0, v7
s_nop 1
v_cndmask_b32 v16, 0, v4, vcc
v_cmp_eq_u32 vcc, 1, v7
s_nop 1
v_cndmask_b32 v17, 0, v4, vcc
v_cmp_eq_u32 vcc, 2, v7
s_nop 1
v_cndmask_b32 v18, 0, v4, vcc
v_cmp_eq_u32 vcc, 3, v7
s_nop 1
v_cndmask_b32 v19, 0, v4, vcc
s_waitcnt lgkmcnt(0)
v_add_f32 v32, v32, v33
v_add_f32 v34, v34, v35
v_add_f32 v36, v36, v37
v_add_f32 v38, v38, v39
v_add_f32 v40, v40, v41
v_add_f32 v42, v42, v43
v_add_f32 v44, v44, v45
v_add_f32 v46, v46, v47
v_add_f32 v32, v32, v34
v_add_f32 v36, v36, v38
v_add_f32 v40, v40, v42
v_add_f32 v44, v44, v46
v_add_f32 v32, v32, v36
v_add_f32 v40, v40, v44
v_add_f32 v32, v32, v40
v_rcp_f32 v32, v32
s_nop 0
v_mul_f32 v48, v48, v32
v_mul_f32 v49, v49, v32
v_mul_f32 v50, v50, v32
v_mul_f32 v51, v51, v32
v_mul_f32 v52, v52, v32
v_mul_f32 v53, v53, v32
v_mul_f32 v54, v54, v32
v_mul_f32 v55, v55, v32
v_mul_f32 v56, v56, v32
v_mul_f32 v57, v57, v32
v_mul_f32 v58, v58, v32
v_mul_f32 v59, v59, v32
v_mul_f32 v60, v60, v32
v_mul_f32 v61, v61, v32
v_mul_f32 v62, v62, v32
v_mul_f32 v63, v63, v32
v_cvt_pk_bf16_f32 v48, v48, v48
v_cvt_pk_bf16_f32 v49, v49, v49
v_cvt_pk_bf16_f32 v50, v50, v50
v_cvt_pk_bf16_f32 v51, v51, v51
v_cvt_pk_bf16_f32 v52, v52, v52
v_cvt_pk_bf16_f32 v53, v53, v53
v_cvt_pk_bf16_f32 v54, v54, v54
v_cvt_pk_bf16_f32 v55, v55, v55
v_cvt_pk_bf16_f32 v56, v56, v56
v_cvt_pk_bf16_f32 v57, v57, v57
v_cvt_pk_bf16_f32 v58, v58, v58
v_cvt_pk_bf16_f32 v59, v59, v59
v_cvt_pk_bf16_f32 v60, v60, v60
v_cvt_pk_bf16_f32 v61, v61, v61
v_cvt_pk_bf16_f32 v62, v62, v62
v_cvt_pk_bf16_f32 v63, v63, v63
ds_write_b32 v14, v49 offset:256
ds_write_b32 v14, v50 offset:512
ds_write_b32 v14, v51 offset:768
ds_write_b32 v14, v52 offset:1024
ds_write_b32 v14, v53 offset:1280
ds_write_b32 v14, v54 offset:1536
ds_write_b32 v14, v55 offset:1792
ds_write_b32 v14, v56 offset:2048
ds_write_b32 v14, v57 offset:2304
ds_write_b32 v14, v58 offset:2560
ds_write_b32 v14, v59 offset:2816
ds_write_b32 v14, v60 offset:3072
ds_write_b32 v14, v61 offset:3328
ds_write_b32 v14, v62 offset:3584
ds_write_b32 v14, v63 offset:3840
v_mov_b32 v13, v48
v_add_u32 v14, 256, v14
v_mov_b32 v28, 0
v_mov_b32 v29, 0
v_mov_b32 v30, 0
v_mov_b32 v31, 0
s_waitcnt lgkmcnt(0)
v_mov_b32 v12, v13
s_waitcnt lgkmcnt(0)
v_readfirstlane_b32 s3, v200
ds_read_b32 v200, v201
ds_read_b32 v13, v14
v_add_u32 v14, 256, v14
s_waitcnt vmcnt(15)
v_and_b32_dpp v20, v12, v16 row_newbcast:0 row_mask:0xf bank_mask:0xf
v_and_b32_dpp v21, v12, v17 row_newbcast:0 row_mask:0xf bank_mask:0xf
v_and_b32_dpp v22, v12, v18 row_newbcast:0 row_mask:0xf bank_mask:0xf
v_and_b32_dpp v23, v12, v19 row_newbcast:0 row_mask:0xf bank_mask:0xf
s_nop 1
v_mfma_f32_16x16x32_bf16 v[28:31], v[64:67], v[20:23], v[28:31]
s_waitcnt vmcnt(14)
v_and_b32_dpp v24, v12, v16 row_newbcast:1 row_mask:0xf bank_mask:0xf
v_and_b32_dpp v25, v12, v17 row_newbcast:1 row_mask:0xf bank_mask:0xf
v_and_b32_dpp v26, v12, v18 row_newbcast:1 row_mask:0xf bank_mask:0xf
v_and_b32_dpp v27, v12, v19 row_newbcast:1 row_mask:0xf bank_mask:0xf
s_nop 1
v_mfma_f32_16x16x32_bf16 v[28:31], v[68:71], v[24:27], v[28:31]
s_waitcnt vmcnt(13)
v_and_b32_dpp v20, v12, v16 row_newbcast:2 row_mask:0xf bank_mask:0xf
v_and_b32_dpp v21, v12, v17 row_newbcast:2 row_mask:0xf bank_mask:0xf
v_and_b32_dpp v22, v12, v18 row_newbcast:2 row_mask:0xf bank_mask:0xf
v_and_b32_dpp v23, v12, v19 row_newbcast:2 row_mask:0xf bank_mask:0xf
s_nop 1
v_mfma_f32_16x16x32_bf16 v[28:31], v[72:75], v[20:23], v[28:31]
s_waitcnt vmcnt(12)
v_and_b32_dpp v24, v12, v16 row_newbcast:3 row_mask:0xf bank_mask:0xf
v_and_b32_dpp v25, v12, v17 row_newbcast:3 row_mask:0xf bank_mask:0xf
v_and_b32_dpp v26, v12, v18 row_newbcast:3 row_mask:0xf bank_mask:0xf
v_and_b32_dpp v27, v12, v19 row_newbcast:3 row_mask:0xf bank_mask:0xf
s_nop 1
v_mfma_f32_16x16x32_bf16 v[28:31], v[76:79], v[24:27], v[28:31]
s_waitcnt vmcnt(11)
v_and_b32_dpp v20, v12, v16 row_newbcast:4 row_mask:0xf bank_mask:0xf
v_and_b32_dpp v21, v12, v17 row_newbcast:4 row_mask:0xf bank_mask:0xf
v_and_b32_dpp v22, v12, v18 row_newbcast:4 row_mask:0xf bank_mask:0xf
v_and_b32_dpp v23, v12, v19 row_newbcast:4 row_mask:0xf bank_mask:0xf
s_nop 1
v_mfma_f32_16x16x32_bf16 v[28:31], v[80:83], v[20:23], v[28:31]
s_waitcnt vmcnt(10)
v_and_b32_dpp v24, v12, v16 row_newbcast:5 row_mask:0xf bank_mask:0xf
v_and_b32_dpp v25, v12, v17 row_newbcast:5 row_mask:0xf bank_mask:0xf
v_and_b32_dpp v26, v12, v18 row_newbcast:5 row_mask:0xf bank_mask:0xf
v_and_b32_dpp v27, v12, v19 row_newbcast:5 row_mask:0xf bank_mask:0xf
s_nop 1
v_mfma_f32_16x16x32_bf16 v[28:31], v[84:87], v[24:27], v[28:31]
s_waitcnt vmcnt(9)
v_and_b32_dpp v20, v12, v16 row_newbcast:6 row_mask:0xf bank_mask:0xf
v_and_b32_dpp v21, v12, v17 row_newbcast:6 row_mask:0xf bank_mask:0xf
v_and_b32_dpp v22, v12, v18 row_newbcast:6 row_mask:0xf bank_mask:0xf
v_and_b32_dpp v23, v12, v19 row_newbcast:6 row_mask:0xf bank_mask:0xf
s_nop 1
v_mfma_f32_16x16x32_bf16 v[28:31], v[88:91], v[20:23], v[28:31]
s_waitcnt vmcnt(8)
v_and_b32_dpp v24, v12, v16 row_newbcast:7 row_mask:0xf bank_mask:0xf
v_and_b32_dpp v25, v12, v17 row_newbcast:7 row_mask:0xf bank_mask:0xf
v_and_b32_dpp v26, v12, v18 row_newbcast:7 row_mask:0xf bank_mask:0xf
v_and_b32_dpp v27, v12, v19 row_newbcast:7 row_mask:0xf bank_mask:0xf
s_nop 1
v_mfma_f32_16x16x32_bf16 v[28:31], v[92:95], v[24:27], v[28:31]
s_waitcnt vmcnt(7)
v_and_b32_dpp v20, v12, v16 row_newbcast:8 row_mask:0xf bank_mask:0xf
v_and_b32_dpp v21, v12, v17 row_newbcast:8 row_mask:0xf bank_mask:0xf
v_and_b32_dpp v22, v12, v18 row_newbcast:8 row_mask:0xf bank_mask:0xf
v_and_b32_dpp v23, v12, v19 row_newbcast:8 row_mask:0xf bank_mask:0xf
s_nop 1
v_mfma_f32_16x16x32_bf16 v[28:31], v[96:99], v[20:23], v[28:31]
s_waitcnt vmcnt(6)
v_and_b32_dpp v24, v12, v16 row_newbcast:9 row_mask:0xf bank_mask:0xf
v_and_b32_dpp v25, v12, v17 row_newbcast:9 row_mask:0xf bank_mask:0xf
v_and_b32_dpp v26, v12, v18 row_newbcast:9 row_mask:0xf bank_mask:0xf
v_and_b32_dpp v27, v12, v19 row_newbcast:9 row_mask:0xf bank_mask:0xf
s_nop 1
v_mfma_f32_16x16x32_bf16 v[28:31], v[100:103], v[24:27], v[28:31]
s_waitcnt vmcnt(5)
s_cmp_ge_u32 s3, 6
s_cbranch_scc1 L109
s_waitcnt vmcnt(4)
L109:
buffer_load_dwordx4 v[128:131], v2, s[44:47], s82 offen nt
s_add_u32 s82, s82, 4096
v_and_b32_dpp v20, v12, v16 row_newbcast:10 row_mask:0xf bank_mask:0xf
v_and_b32_dpp v21, v12, v17 row_newbcast:10 row_mask:0xf bank_mask:0xf
v_and_b32_dpp v22, v12, v18 row_newbcast:10 row_mask:0xf bank_mask:0xf
v_and_b32_dpp v23, v12, v19 row_newbcast:10 row_mask:0xf bank_mask:0xf
s_nop 1
v_mfma_f32_16x16x32_bf16 v[28:31], v[104:107], v[20:23], v[28:31]
s_waitcnt vmcnt(5)
s_cmp_ge_u32 s3, 6
s_cbranch_scc1 L110
s_waitcnt vmcnt(4)
L110:
buffer_load_dwordx4 v[132:135], v2, s[44:47], s82 offen nt
s_add_u32 s82, s82, 4096
v_and_b32_dpp v24, v12, v16 row_newbcast:11 row_mask:0xf bank_mask:0xf
v_and_b32_dpp v25, v12, v17 row_newbcast:11 row_mask:0xf bank_mask:0xf
v_and_b32_dpp v26, v12, v18 row_newbcast:11 row_mask:0xf bank_mask:0xf
v_and_b32_dpp v27, v12, v19 row_newbcast:11 row_mask:0xf bank_mask:0xf
s_nop 1
v_mfma_f32_16x16x32_bf16 v[28:31], v[108:111], v[24:27], v[28:31]
s_waitcnt vmcnt(5)
s_cmp_ge_u32 s3, 6
s_cbranch_scc1 L111
s_waitcnt vmcnt(4)
L111:
buffer_load_dwordx4 v[136:139], v2, s[44:47], s82 offen nt
s_add_u32 s82, s82, 4096
v_and_b32_dpp v20, v12, v16 row_newbcast:12 row_mask:0xf bank_mask:0xf
v_and_b32_dpp v21, v12, v17 row_newbcast:12 row_mask:0xf bank_mask:0xf
v_and_b32_dpp v22, v12, v18 row_newbcast:12 row_mask:0xf bank_mask:0xf
v_and_b32_dpp v23, v12, v19 row_newbcast:12 row_mask:0xf bank_mask:0xf
s_nop 1
v_mfma_f32_16x16x32_bf16 v[28:31], v[112:115], v[20:23], v[28:31]
s_waitcnt vmcnt(5)
s_cmp_ge_u32 s3, 6
s_cbranch_scc1 L112
s_waitcnt vmcnt(4)
L112:
buffer_load_dwordx4 v[140:143], v2, s[44:47], s82 offen nt
s_add_u32 s82, s82, 4096
v_and_b32_dpp v24, v12, v16 row_newbcast:13 row_mask:0xf bank_mask:0xf
v_and_b32_dpp v25, v12, v17 row_newbcast:13 row_mask:0xf bank_mask:0xf
v_and_b32_dpp v26, v12, v18 row_newbcast:13 row_mask:0xf bank_mask:0xf
v_and_b32_dpp v27, v12, v19 row_newbcast:13 row_mask:0xf bank_mask:0xf
s_nop 1
v_mfma_f32_16x16x32_bf16 v[28:31], v[116:119], v[24:27], v[28:31]
s_waitcnt vmcnt(5)
s_cmp_ge_u32 s3, 6
s_cbranch_scc1 L113
s_waitcnt vmcnt(4)
L113:
buffer_load_dwordx4 v[144:147], v2, s[44:47], s82 offen nt
s_add_u32 s82, s82, 4096
v_and_b32_dpp v20, v12, v16 row_newbcast:14 row_mask:0xf bank_mask:0xf
v_and_b32_dpp v21, v12, v17 row_newbcast:14 row_mask:0xf bank_mask:0xf
v_and_b32_dpp v22, v12, v18 row_newbcast:14 row_mask:0xf bank_mask:0xf
v_and_b32_dpp v23, v12, v19 row_newbcast:14 row_mask:0xf bank_mask:0xf
s_nop 1
v_mfma_f32_16x16x32_bf16 v[28:31], v[120:123], v[20:23], v[28:31]
s_waitcnt vmcnt(5)
s_cmp_ge_u32 s3, 6
s_cbranch_scc1 L114
s_waitcnt vmcnt(4)
L114:
buffer_load_dwordx4 v[148:151], v2, s[44:47], s82 offen nt
s_add_u32 s82, s82, 4096
v_and_b32_dpp v24, v12, v16 row_newbcast:15 row_mask:0xf bank_mask:0xf
v_and_b32_dpp v25, v12, v17 row_newbcast:15 row_mask:0xf bank_mask:0xf
v_and_b32_dpp v26, v12, v18 row_newbcast:15 row_mask:0xf bank_mask:0xf
v_and_b32_dpp v27, v12, v19 row_newbcast:15 row_mask:0xf bank_mask:0xf
s_nop 1
v_mfma_f32_16x16x32_bf16 v[28:31], v[124:127], v[24:27], v[28:31]
v_add_u32 v202, 1, v202
s_cmp_eq_u32 s75, 0
s_cbranch_scc0 L115
ds_write_b32 v203, v202
L115:
s_mov_b32 s79, 0
L116:
s_waitcnt lgkmcnt(0)
v_mov_b32 v12, v13
s_waitcnt lgkmcnt(0)
v_readfirstlane_b32 s3, v200
ds_read_b32 v200, v201
ds_read_b32 v13, v14
v_add_u32 v14, 256, v14
s_waitcnt vmcnt(5)
s_cmp_ge_u32 s3, 6
s_cbranch_scc1 L117
s_waitcnt vmcnt(4)
L117:
buffer_load_dwordx4 v[152:155], v2, s[44:47], s82 offen nt
s_add_u32 s82, s82, 4096
v_and_b32_dpp v20, v12, v16 row_newbcast:0 row_mask:0xf bank_mask:0xf
v_and_b32_dpp v21, v12, v17 row_newbcast:0 row_mask:0xf bank_mask:0xf
v_and_b32_dpp v22, v12, v18 row_newbcast:0 row_mask:0xf bank_mask:0xf
v_and_b32_dpp v23, v12, v19 row_newbcast:0 row_mask:0xf bank_mask:0xf
s_nop 1
v_mfma_f32_16x16x32_bf16 v[28:31], v[128:131], v[20:23], v[28:31]
s_waitcnt vmcnt(5)
s_cmp_ge_u32 s3, 6
s_cbranch_scc1 L118
s_waitcnt vmcnt(4)
L118:
buffer_load_dwordx4 v[156:159], v2, s[44:47], s82 offen nt
s_add_u32 s82, s82, 4096
v_and_b32_dpp v24, v12, v16 row_newbcast:1 row_mask:0xf bank_mask:0xf
v_and_b32_dpp v25, v12, v17 row_newbcast:1 row_mask:0xf bank_mask:0xf
v_and_b32_dpp v26, v12, v18 row_newbcast:1 row_mask:0xf bank_mask:0xf
v_and_b32_dpp v27, v12, v19 row_newbcast:1 row_mask:0xf bank_mask:0xf
s_nop 1
v_mfma_f32_16x16x32_bf16 v[28:31], v[132:135], v[24:27], v[28:31]
s_waitcnt vmcnt(5)
s_cmp_ge_u32 s3, 6
s_cbranch_scc1 L119
s_waitcnt vmcnt(4)
L119:
buffer_load_dwordx4 v[160:163], v2, s[44:47], s82 offen nt
s_add_u32 s82, s82, 4096
v_and_b32_dpp v20, v12, v16 row_newbcast:2 row_mask:0xf bank_mask:0xf
v_and_b32_dpp v21, v12, v17 row_newbcast:2 row_mask:0xf bank_mask:0xf
v_and_b32_dpp v22, v12, v18 row_newbcast:2 row_mask:0xf bank_mask:0xf
v_and_b32_dpp v23, v12, v19 row_newbcast:2 row_mask:0xf bank_mask:0xf
s_nop 1
v_mfma_f32_16x16x32_bf16 v[28:31], v[136:139], v[20:23], v[28:31]
s_waitcnt vmcnt(5)
s_cmp_ge_u32 s3, 6
s_cbranch_scc1 L120
s_waitcnt vmcnt(4)
L120:
buffer_load_dwordx4 v[164:167], v2, s[44:47], s82 offen nt
s_add_u32 s82, s82, 4096
v_and_b32_dpp v24, v12, v16 row_newbcast:3 row_mask:0xf bank_mask:0xf
v_and_b32_dpp v25, v12, v17 row_newbcast:3 row_mask:0xf bank_mask:0xf
v_and_b32_dpp v26, v12, v18 row_newbcast:3 row_mask:0xf bank_mask:0xf
v_and_b32_dpp v27, v12, v19 row_newbcast:3 row_mask:0xf bank_mask:0xf
s_nop 1
v_mfma_f32_16x16x32_bf16 v[28:31], v[140:143], v[24:27], v[28:31]
s_waitcnt vmcnt(5)
s_cmp_ge_u32 s3, 6
s_cbranch_scc1 L121
s_waitcnt vmcnt(4)
L121:
buffer_load_dwordx4 v[168:171], v2, s[44:47], s82 offen nt
s_add_u32 s82, s82, 4096
v_and_b32_dpp v20, v12, v16 row_newbcast:4 row_mask:0xf bank_mask:0xf
v_and_b32_dpp v21, v12, v17 row_newbcast:4 row_mask:0xf bank_mask:0xf
v_and_b32_dpp v22, v12, v18 row_newbcast:4 row_mask:0xf bank_mask:0xf
v_and_b32_dpp v23, v12, v19 row_newbcast:4 row_mask:0xf bank_mask:0xf
s_nop 1
v_mfma_f32_16x16x32_bf16 v[28:31], v[144:147], v[20:23], v[28:31]
s_waitcnt vmcnt(5)
s_cmp_ge_u32 s3, 6
s_cbranch_scc1 L122
s_waitcnt vmcnt(4)
L122:
buffer_load_dwordx4 v[172:175], v2, s[44:47], s82 offen nt
s_add_u32 s82, s82, 4096
v_and_b32_dpp v24, v12, v16 row_newbcast:5 row_mask:0xf bank_mask:0xf
v_and_b32_dpp v25, v12, v17 row_newbcast:5 row_mask:0xf bank_mask:0xf
v_and_b32_dpp v26, v12, v18 row_newbcast:5 row_mask:0xf bank_mask:0xf
v_and_b32_dpp v27, v12, v19 row_newbcast:5 row_mask:0xf bank_mask:0xf
s_nop 1
v_mfma_f32_16x16x32_bf16 v[28:31], v[148:151], v[24:27], v[28:31]
s_waitcnt vmcnt(5)
s_cmp_ge_u32 s3, 6
s_cbranch_scc1 L123
s_waitcnt vmcnt(4)
L123:
buffer_load_dwordx4 v[176:179], v2, s[44:47], s82 offen nt
s_add_u32 s82, s82, 4096
v_and_b32_dpp v20, v12, v16 row_newbcast:6 row_mask:0xf bank_mask:0xf
v_and_b32_dpp v21, v12, v17 row_newbcast:6 row_mask:0xf bank_mask:0xf
v_and_b32_dpp v22, v12, v18 row_newbcast:6 row_mask:0xf bank_mask:0xf
v_and_b32_dpp v23, v12, v19 row_newbcast:6 row_mask:0xf bank_mask:0xf
s_nop 1
v_mfma_f32_16x16x32_bf16 v[28:31], v[152:155], v[20:23], v[28:31]
s_waitcnt vmcnt(5)
s_cmp_ge_u32 s3, 6
s_cbranch_scc1 L124
s_waitcnt vmcnt(4)
L124:
buffer_load_dwordx4 v[180:183], v2, s[44:47], s82 offen nt
s_add_u32 s82, s82, 4096
v_and_b32_dpp v24, v12, v16 row_newbcast:7 row_mask:0xf bank_mask:0xf
v_and_b32_dpp v25, v12, v17 row_newbcast:7 row_mask:0xf bank_mask:0xf
v_and_b32_dpp v26, v12, v18 row_newbcast:7 row_mask:0xf bank_mask:0xf
v_and_b32_dpp v27, v12, v19 row_newbcast:7 row_mask:0xf bank_mask:0xf
s_nop 1
v_mfma_f32_16x16x32_bf16 v[28:31], v[156:159], v[24:27], v[28:31]
s_waitcnt vmcnt(5)
s_cmp_ge_u32 s3, 6
s_cbranch_scc1 L125
s_waitcnt vmcnt(4)
L125:
buffer_load_dwordx4 v[184:187], v2, s[44:47], s82 offen nt
s_add_u32 s82, s82, 4096
v_and_b32_dpp v20, v12, v16 row_newbcast:8 row_mask:0xf bank_mask:0xf
v_and_b32_dpp v21, v12, v17 row_newbcast:8 row_mask:0xf bank_mask:0xf
v_and_b32_dpp v22, v12, v18 row_newbcast:8 row_mask:0xf bank_mask:0xf
v_and_b32_dpp v23, v12, v19 row_newbcast:8 row_mask:0xf bank_mask:0xf
s_nop 1
v_mfma_f32_16x16x32_bf16 v[28:31], v[160:163], v[20:23], v[28:31]
s_waitcnt vmcnt(5)
s_cmp_ge_u32 s3, 6
s_cbranch_scc1 L126
s_waitcnt vmcnt(4)
L126:
buffer_load_dwordx4 v[188:191], v2, s[44:47], s82 offen nt
s_add_u32 s82, s82, 4096
v_and_b32_dpp v24, v12, v16 row_newbcast:9 row_mask:0xf bank_mask:0xf
v_and_b32_dpp v25, v12, v17 row_newbcast:9 row_mask:0xf bank_mask:0xf
v_and_b32_dpp v26, v12, v18 row_newbcast:9 row_mask:0xf bank_mask:0xf
v_and_b32_dpp v27, v12, v19 row_newbcast:9 row_mask:0xf bank_mask:0xf
s_nop 1
v_mfma_f32_16x16x32_bf16 v[28:31], v[164:167], v[24:27], v[28:31]
s_waitcnt vmcnt(5)
s_cmp_ge_u32 s3, 6
s_cbranch_scc1 L127
s_waitcnt vmcnt(4)
L127:
buffer_load_dwordx4 v[64:67], v2, s[44:47], s82 offen nt
s_add_u32 s82, s82, 4096
v_and_b32_dpp v20, v12, v16 row_newbcast:10 row_mask:0xf bank_mask:0xf
v_and_b32_dpp v21, v12, v17 row_newbcast:10 row_mask:0xf bank_mask:0xf
v_and_b32_dpp v22, v12, v18 row_newbcast:10 row_mask:0xf bank_mask:0xf
v_and_b32_dpp v23, v12, v19 row_newbcast:10 row_mask:0xf bank_mask:0xf
s_nop 1
v_mfma_f32_16x16x32_bf16 v[28:31], v[168:171], v[20:23], v[28:31]
s_waitcnt vmcnt(5)
s_cmp_ge_u32 s3, 6
s_cbranch_scc1 L128
s_waitcnt vmcnt(4)
L128:
buffer_load_dwordx4 v[68:71], v2, s[44:47], s82 offen nt
s_add_u32 s82, s82, 4096
v_and_b32_dpp v24, v12, v16 row_newbcast:11 row_mask:0xf bank_mask:0xf
v_and_b32_dpp v25, v12, v17 row_newbcast:11 row_mask:0xf bank_mask:0xf
v_and_b32_dpp v26, v12, v18 row_newbcast:11 row_mask:0xf bank_mask:0xf
v_and_b32_dpp v27, v12, v19 row_newbcast:11 row_mask:0xf bank_mask:0xf
s_nop 1
v_mfma_f32_16x16x32_bf16 v[28:31], v[172:175], v[24:27], v[28:31]
s_waitcnt vmcnt(5)
s_cmp_ge_u32 s3, 6
s_cbranch_scc1 L129
s_waitcnt vmcnt(4)
L129:
buffer_load_dwordx4 v[72:75], v2, s[44:47], s82 offen nt
s_add_u32 s82, s82, 4096
v_and_b32_dpp v20, v12, v16 row_newbcast:12 row_mask:0xf bank_mask:0xf
v_and_b32_dpp v21, v12, v17 row_newbcast:12 row_mask:0xf bank_mask:0xf
v_and_b32_dpp v22, v12, v18 row_newbcast:12 row_mask:0xf bank_mask:0xf
v_and_b32_dpp v23, v12, v19 row_newbcast:12 row_mask:0xf bank_mask:0xf
s_nop 1
v_mfma_f32_16x16x32_bf16 v[28:31], v[176:179], v[20:23], v[28:31]
s_waitcnt vmcnt(5)
s_cmp_ge_u32 s3, 6
s_cbranch_scc1 L130
s_waitcnt vmcnt(4)
L130:
buffer_load_dwordx4 v[76:79], v2, s[44:47], s82 offen nt
s_add_u32 s82, s82, 4096
v_and_b32_dpp v24, v12, v16 row_newbcast:13 row_mask:0xf bank_mask:0xf
v_and_b32_dpp v25, v12, v17 row_newbcast:13 row_mask:0xf bank_mask:0xf
v_and_b32_dpp v26, v12, v18 row_newbcast:13 row_mask:0xf bank_mask:0xf
v_and_b32_dpp v27, v12, v19 row_newbcast:13 row_mask:0xf bank_mask:0xf
s_nop 1
v_mfma_f32_16x16x32_bf16 v[28:31], v[180:183], v[24:27], v[28:31]
s_waitcnt vmcnt(5)
s_cmp_ge_u32 s3, 6
s_cbranch_scc1 L131
s_waitcnt vmcnt(4)
L131:
buffer_load_dwordx4 v[80:83], v2, s[44:47], s82 offen nt
s_add_u32 s82, s82, 4096
v_and_b32_dpp v20, v12, v16 row_newbcast:14 row_mask:0xf bank_mask:0xf
v_and_b32_dpp v21, v12, v17 row_newbcast:14 row_mask:0xf bank_mask:0xf
v_and_b32_dpp v22, v12, v18 row_newbcast:14 row_mask:0xf bank_mask:0xf
v_and_b32_dpp v23, v12, v19 row_newbcast:14 row_mask:0xf bank_mask:0xf
s_nop 1
v_mfma_f32_16x16x32_bf16 v[28:31], v[184:187], v[20:23], v[28:31]
s_waitcnt vmcnt(5)
s_cmp_ge_u32 s3, 6
s_cbranch_scc1 L132
s_waitcnt vmcnt(4)
L132:
buffer_load_dwordx4 v[84:87], v2, s[44:47], s82 offen nt
s_add_u32 s82, s82, 4096
v_and_b32_dpp v24, v12, v16 row_newbcast:15 row_mask:0xf bank_mask:0xf
v_and_b32_dpp v25, v12, v17 row_newbcast:15 row_mask:0xf bank_mask:0xf
v_and_b32_dpp v26, v12, v18 row_newbcast:15 row_mask:0xf bank_mask:0xf
v_and_b32_dpp v27, v12, v19 row_newbcast:15 row_mask:0xf bank_mask:0xf
s_nop 1
v_mfma_f32_16x16x32_bf16 v[28:31], v[188:191], v[24:27], v[28:31]
v_add_u32 v202, 1, v202
s_cmp_eq_u32 s75, 0
s_cbranch_scc0 L133
ds_write_b32 v203, v202
L133:
s_waitcnt lgkmcnt(0)
v_mov_b32 v12, v13
s_waitcnt lgkmcnt(0)
v_readfirstlane_b32 s3, v200
ds_read_b32 v200, v201
ds_read_b32 v13, v14
v_add_u32 v14, 256, v14
s_waitcnt vmcnt(5)
s_cmp_ge_u32 s3, 6
s_cbranch_scc1 L134
s_waitcnt vmcnt(4)
L134:
buffer_load_dwordx4 v[88:91], v2, s[44:47], s82 offen nt
s_add_u32 s82, s82, 4096
v_and_b32_dpp v20, v12, v16 row_newbcast:0 row_mask:0xf bank_mask:0xf
v_and_b32_dpp v21, v12, v17 row_newbcast:0 row_mask:0xf bank_mask:0xf
v_and_b32_dpp v22, v12, v18 row_newbcast:0 row_mask:0xf bank_mask:0xf
v_and_b32_dpp v23, v12, v19 row_newbcast:0 row_mask:0xf bank_mask:0xf
s_nop 1
v_mfma_f32_16x16x32_bf16 v[28:31], v[64:67], v[20:23], v[28:31]
s_waitcnt vmcnt(5)
s_cmp_ge_u32 s3, 6
s_cbranch_scc1 L135
s_waitcnt vmcnt(4)
L135:
buffer_load_dwordx4 v[92:95], v2, s[44:47], s82 offen nt
s_add_u32 s82, s82, 4096
v_and_b32_dpp v24, v12, v16 row_newbcast:1 row_mask:0xf bank_mask:0xf
v_and_b32_dpp v25, v12, v17 row_newbcast:1 row_mask:0xf bank_mask:0xf
v_and_b32_dpp v26, v12, v18 row_newbcast:1 row_mask:0xf bank_mask:0xf
v_and_b32_dpp v27, v12, v19 row_newbcast:1 row_mask:0xf bank_mask:0xf
s_nop 1
v_mfma_f32_16x16x32_bf16 v[28:31], v[68:71], v[24:27], v[28:31]
s_waitcnt vmcnt(5)
s_cmp_ge_u32 s3, 6
s_cbranch_scc1 L136
s_waitcnt vmcnt(4)
L136:
buffer_load_dwordx4 v[96:99], v2, s[44:47], s82 offen nt
s_add_u32 s82, s82, 4096
v_and_b32_dpp v20, v12, v16 row_newbcast:2 row_mask:0xf bank_mask:0xf
v_and_b32_dpp v21, v12, v17 row_newbcast:2 row_mask:0xf bank_mask:0xf
v_and_b32_dpp v22, v12, v18 row_newbcast:2 row_mask:0xf bank_mask:0xf
v_and_b32_dpp v23, v12, v19 row_newbcast:2 row_mask:0xf bank_mask:0xf
s_nop 1
v_mfma_f32_16x16x32_bf16 v[28:31], v[72:75], v[20:23], v[28:31]
s_waitcnt vmcnt(5)
s_cmp_ge_u32 s3, 6
s_cbranch_scc1 L137
s_waitcnt vmcnt(4)
L137:
buffer_load_dwordx4 v[100:103], v2, s[44:47], s82 offen nt
s_add_u32 s82, s82, 4096
v_and_b32_dpp v24, v12, v16 row_newbcast:3 row_mask:0xf bank_mask:0xf
v_and_b32_dpp v25, v12, v17 row_newbcast:3 row_mask:0xf bank_mask:0xf
v_and_b32_dpp v26, v12, v18 row_newbcast:3 row_mask:0xf bank_mask:0xf
v_and_b32_dpp v27, v12, v19 row_newbcast:3 row_mask:0xf bank_mask:0xf
s_nop 1
v_mfma_f32_16x16x32_bf16 v[28:31], v[76:79], v[24:27], v[28:31]
s_waitcnt vmcnt(5)
s_cmp_ge_u32 s3, 6
s_cbranch_scc1 L138
s_waitcnt vmcnt(4)
L138:
buffer_load_dwordx4 v[104:107], v2, s[44:47], s82 offen nt
s_add_u32 s82, s82, 4096
v_and_b32_dpp v20, v12, v16 row_newbcast:4 row_mask:0xf bank_mask:0xf
v_and_b32_dpp v21, v12, v17 row_newbcast:4 row_mask:0xf bank_mask:0xf
v_and_b32_dpp v22, v12, v18 row_newbcast:4 row_mask:0xf bank_mask:0xf
v_and_b32_dpp v23, v12, v19 row_newbcast:4 row_mask:0xf bank_mask:0xf
s_nop 1
v_mfma_f32_16x16x32_bf16 v[28:31], v[80:83], v[20:23], v[28:31]
s_waitcnt vmcnt(5)
s_cmp_ge_u32 s3, 6
s_cbranch_scc1 L139
s_waitcnt vmcnt(4)
L139:
buffer_load_dwordx4 v[108:111], v2, s[44:47], s82 offen nt
s_add_u32 s82, s82, 4096
v_and_b32_dpp v24, v12, v16 row_newbcast:5 row_mask:0xf bank_mask:0xf
v_and_b32_dpp v25, v12, v17 row_newbcast:5 row_mask:0xf bank_mask:0xf
v_and_b32_dpp v26, v12, v18 row_newbcast:5 row_mask:0xf bank_mask:0xf
v_and_b32_dpp v27, v12, v19 row_newbcast:5 row_mask:0xf bank_mask:0xf
s_nop 1
v_mfma_f32_16x16x32_bf16 v[28:31], v[84:87], v[24:27], v[28:31]
s_waitcnt vmcnt(5)
s_cmp_ge_u32 s3, 6
s_cbranch_scc1 L140
s_waitcnt vmcnt(4)
L140:
buffer_load_dwordx4 v[112:115], v2, s[44:47], s82 offen nt
s_add_u32 s82, s82, 4096
v_and_b32_dpp v20, v12, v16 row_newbcast:6 row_mask:0xf bank_mask:0xf
v_and_b32_dpp v21, v12, v17 row_newbcast:6 row_mask:0xf bank_mask:0xf
v_and_b32_dpp v22, v12, v18 row_newbcast:6 row_mask:0xf bank_mask:0xf
v_and_b32_dpp v23, v12, v19 row_newbcast:6 row_mask:0xf bank_mask:0xf
s_nop 1
v_mfma_f32_16x16x32_bf16 v[28:31], v[88:91], v[20:23], v[28:31]
s_waitcnt vmcnt(5)
s_cmp_ge_u32 s3, 6
s_cbranch_scc1 L141
s_waitcnt vmcnt(4)
L141:
buffer_load_dwordx4 v[116:119], v2, s[44:47], s82 offen nt
s_add_u32 s82, s82, 4096
v_and_b32_dpp v24, v12, v16 row_newbcast:7 row_mask:0xf bank_mask:0xf
v_and_b32_dpp v25, v12, v17 row_newbcast:7 row_mask:0xf bank_mask:0xf
v_and_b32_dpp v26, v12, v18 row_newbcast:7 row_mask:0xf bank_mask:0xf
v_and_b32_dpp v27, v12, v19 row_newbcast:7 row_mask:0xf bank_mask:0xf
s_nop 1
v_mfma_f32_16x16x32_bf16 v[28:31], v[92:95], v[24:27], v[28:31]
s_waitcnt vmcnt(5)
s_cmp_ge_u32 s3, 6
s_cbranch_scc1 L142
s_waitcnt vmcnt(4)
L142:
buffer_load_dwordx4 v[120:123], v2, s[44:47], s82 offen nt
s_add_u32 s82, s82, 4096
v_and_b32_dpp v20, v12, v16 row_newbcast:8 row_mask:0xf bank_mask:0xf
v_and_b32_dpp v21, v12, v17 row_newbcast:8 row_mask:0xf bank_mask:0xf
v_and_b32_dpp v22, v12, v18 row_newbcast:8 row_mask:0xf bank_mask:0xf
v_and_b32_dpp v23, v12, v19 row_newbcast:8 row_mask:0xf bank_mask:0xf
s_nop 1
v_mfma_f32_16x16x32_bf16 v[28:31], v[96:99], v[20:23], v[28:31]
s_waitcnt vmcnt(5)
s_cmp_ge_u32 s3, 6
s_cbranch_scc1 L143
s_waitcnt vmcnt(4)
L143:
buffer_load_dwordx4 v[124:127], v2, s[44:47], s82 offen nt
s_add_u32 s82, s82, 4096
v_and_b32_dpp v24, v12, v16 row_newbcast:9 row_mask:0xf bank_mask:0xf
v_and_b32_dpp v25, v12, v17 row_newbcast:9 row_mask:0xf bank_mask:0xf
v_and_b32_dpp v26, v12, v18 row_newbcast:9 row_mask:0xf bank_mask:0xf
v_and_b32_dpp v27, v12, v19 row_newbcast:9 row_mask:0xf bank_mask:0xf
s_nop 1
v_mfma_f32_16x16x32_bf16 v[28:31], v[100:103], v[24:27], v[28:31]
s_waitcnt vmcnt(5)
s_cmp_ge_u32 s3, 6
s_cbranch_scc1 L144
s_waitcnt vmcnt(4)
L144:
buffer_load_dwordx4 v[128:131], v2, s[44:47], s82 offen nt
s_add_u32 s82, s82, 4096
v_and_b32_dpp v20, v12, v16 row_newbcast:10 row_mask:0xf bank_mask:0xf
v_and_b32_dpp v21, v12, v17 row_newbcast:10 row_mask:0xf bank_mask:0xf
v_and_b32_dpp v22, v12, v18 row_newbcast:10 row_mask:0xf bank_mask:0xf
v_and_b32_dpp v23, v12, v19 row_newbcast:10 row_mask:0xf bank_mask:0xf
s_nop 1
v_mfma_f32_16x16x32_bf16 v[28:31], v[104:107], v[20:23], v[28:31]
s_waitcnt vmcnt(5)
s_cmp_ge_u32 s3, 6
s_cbranch_scc1 L145
s_waitcnt vmcnt(4)
L145:
buffer_load_dwordx4 v[132:135], v2, s[44:47], s82 offen nt
s_add_u32 s82, s82, 4096
v_and_b32_dpp v24, v12, v16 row_newbcast:11 row_mask:0xf bank_mask:0xf
v_and_b32_dpp v25, v12, v17 row_newbcast:11 row_mask:0xf bank_mask:0xf
v_and_b32_dpp v26, v12, v18 row_newbcast:11 row_mask:0xf bank_mask:0xf
v_and_b32_dpp v27, v12, v19 row_newbcast:11 row_mask:0xf bank_mask:0xf
s_nop 1
v_mfma_f32_16x16x32_bf16 v[28:31], v[108:111], v[24:27], v[28:31]
s_waitcnt vmcnt(5)
s_cmp_ge_u32 s3, 6
s_cbranch_scc1 L146
s_waitcnt vmcnt(4)
L146:
buffer_load_dwordx4 v[136:139], v2, s[44:47], s82 offen nt
s_add_u32 s82, s82, 4096
v_and_b32_dpp v20, v12, v16 row_newbcast:12 row_mask:0xf bank_mask:0xf
v_and_b32_dpp v21, v12, v17 row_newbcast:12 row_mask:0xf bank_mask:0xf
v_and_b32_dpp v22, v12, v18 row_newbcast:12 row_mask:0xf bank_mask:0xf
v_and_b32_dpp v23, v12, v19 row_newbcast:12 row_mask:0xf bank_mask:0xf
s_nop 1
v_mfma_f32_16x16x32_bf16 v[28:31], v[112:115], v[20:23], v[28:31]
s_waitcnt vmcnt(5)
s_cmp_ge_u32 s3, 6
s_cbranch_scc1 L147
s_waitcnt vmcnt(4)
L147:
buffer_load_dwordx4 v[140:143], v2, s[44:47], s82 offen nt
s_add_u32 s82, s82, 4096
v_and_b32_dpp v24, v12, v16 row_newbcast:13 row_mask:0xf bank_mask:0xf
v_and_b32_dpp v25, v12, v17 row_newbcast:13 row_mask:0xf bank_mask:0xf
v_and_b32_dpp v26, v12, v18 row_newbcast:13 row_mask:0xf bank_mask:0xf
v_and_b32_dpp v27, v12, v19 row_newbcast:13 row_mask:0xf bank_mask:0xf
s_nop 1
v_mfma_f32_16x16x32_bf16 v[28:31], v[116:119], v[24:27], v[28:31]
s_waitcnt vmcnt(5)
s_cmp_ge_u32 s3, 6
s_cbranch_scc1 L148
s_waitcnt vmcnt(4)
L148:
buffer_load_dwordx4 v[144:147], v2, s[44:47], s82 offen nt
s_add_u32 s82, s82, 4096
v_and_b32_dpp v20, v12, v16 row_newbcast:14 row_mask:0xf bank_mask:0xf
v_and_b32_dpp v21, v12, v17 row_newbcast:14 row_mask:0xf bank_mask:0xf
v_and_b32_dpp v22, v12, v18 row_newbcast:14 row_mask:0xf bank_mask:0xf
v_and_b32_dpp v23, v12, v19 row_newbcast:14 row_mask:0xf bank_mask:0xf
s_nop 1
v_mfma_f32_16x16x32_bf16 v[28:31], v[120:123], v[20:23], v[28:31]
s_waitcnt vmcnt(5)
s_cmp_ge_u32 s3, 6
s_cbranch_scc1 L149
s_waitcnt vmcnt(4)
L149:
buffer_load_dwordx4 v[148:151], v2, s[44:47], s82 offen nt
s_add_u32 s82, s82, 4096
v_and_b32_dpp v24, v12, v16 row_newbcast:15 row_mask:0xf bank_mask:0xf
v_and_b32_dpp v25, v12, v17 row_newbcast:15 row_mask:0xf bank_mask:0xf
v_and_b32_dpp v26, v12, v18 row_newbcast:15 row_mask:0xf bank_mask:0xf
v_and_b32_dpp v27, v12, v19 row_newbcast:15 row_mask:0xf bank_mask:0xf
s_nop 1
v_mfma_f32_16x16x32_bf16 v[28:31], v[124:127], v[24:27], v[28:31]
v_add_u32 v202, 1, v202
s_cmp_eq_u32 s75, 0
s_cbranch_scc0 L150
ds_write_b32 v203, v202
L150:
s_add_u32 s79, s79, 1
s_cmp_lt_u32 s79, 6
s_cbranch_scc1 L116
buffer_load_dwordx4 v[152:155], v2, s[44:47], s82 offen nt
s_add_u32 s82, s82, 4096
buffer_load_dwordx4 v[156:159], v2, s[44:47], s82 offen nt
s_add_u32 s82, s82, 4096
buffer_load_dwordx4 v[160:163], v2, s[44:47], s82 offen nt
s_add_u32 s82, s82, 4096
buffer_load_dwordx4 v[164:167], v2, s[44:47], s82 offen nt
s_add_u32 s82, s82, 4096
s_waitcnt lgkmcnt(0)
v_mov_b32 v12, v13
s_waitcnt lgkmcnt(0)
v_readfirstlane_b32 s3, v200
ds_read_b32 v200, v201
ds_read_b32 v13, v14
v_add_u32 v14, 256, v14
s_waitcnt vmcnt(9)
buffer_load_dwordx4 v[168:171], v2, s[44:47], s82 offen nt
s_add_u32 s82, s82, 4096
v_and_b32_dpp v20, v12, v16 row_newbcast:0 row_mask:0xf bank_mask:0xf
v_and_b32_dpp v21, v12, v17 row_newbcast:0 row_mask:0xf bank_mask:0xf
v_and_b32_dpp v22, v12, v18 row_newbcast:0 row_mask:0xf bank_mask:0xf
v_and_b32_dpp v23, v12, v19 row_newbcast:0 row_mask:0xf bank_mask:0xf
s_nop 1
v_mfma_f32_16x16x32_bf16 v[28:31], v[128:131], v[20:23], v[28:31]
s_waitcnt vmcnt(9)
buffer_load_dwordx4 v[172:175], v2, s[44:47], s82 offen nt
s_add_u32 s82, s82, 4096
v_and_b32_dpp v24, v12, v16 row_newbcast:1 row_mask:0xf bank_mask:0xf
v_and_b32_dpp v25, v12, v17 row_newbcast:1 row_mask:0xf bank_mask:0xf
v_and_b32_dpp v26, v12, v18 row_newbcast:1 row_mask:0xf bank_mask:0xf
v_and_b32_dpp v27, v12, v19 row_newbcast:1 row_mask:0xf bank_mask:0xf
s_nop 1
v_mfma_f32_16x16x32_bf16 v[28:31], v[132:135], v[24:27], v[28:31]
s_waitcnt vmcnt(9)
buffer_load_dwordx4 v[176:179], v2, s[44:47], s82 offen nt
s_add_u32 s82, s82, 4096
v_and_b32_dpp v20, v12, v16 row_newbcast:2 row_mask:0xf bank_mask:0xf
v_and_b32_dpp v21, v12, v17 row_newbcast:2 row_mask:0xf bank_mask:0xf
v_and_b32_dpp v22, v12, v18 row_newbcast:2 row_mask:0xf bank_mask:0xf
v_and_b32_dpp v23, v12, v19 row_newbcast:2 row_mask:0xf bank_mask:0xf
s_nop 1
v_mfma_f32_16x16x32_bf16 v[28:31], v[136:139], v[20:23], v[28:31]
s_waitcnt vmcnt(9)
buffer_load_dwordx4 v[180:183], v2, s[44:47], s82 offen nt
s_add_u32 s82, s82, 4096
v_and_b32_dpp v24, v12, v16 row_newbcast:3 row_mask:0xf bank_mask:0xf
v_and_b32_dpp v25, v12, v17 row_newbcast:3 row_mask:0xf bank_mask:0xf
v_and_b32_dpp v26, v12, v18 row_newbcast:3 row_mask:0xf bank_mask:0xf
v_and_b32_dpp v27, v12, v19 row_newbcast:3 row_mask:0xf bank_mask:0xf
s_nop 1
v_mfma_f32_16x16x32_bf16 v[28:31], v[140:143], v[24:27], v[28:31]
s_waitcnt vmcnt(9)
buffer_load_dwordx4 v[184:187], v2, s[44:47], s82 offen nt
s_add_u32 s82, s82, 4096
v_and_b32_dpp v20, v12, v16 row_newbcast:4 row_mask:0xf bank_mask:0xf
v_and_b32_dpp v21, v12, v17 row_newbcast:4 row_mask:0xf bank_mask:0xf
v_and_b32_dpp v22, v12, v18 row_newbcast:4 row_mask:0xf bank_mask:0xf
v_and_b32_dpp v23, v12, v19 row_newbcast:4 row_mask:0xf bank_mask:0xf
s_nop 1
v_mfma_f32_16x16x32_bf16 v[28:31], v[144:147], v[20:23], v[28:31]
s_waitcnt vmcnt(9)
buffer_load_dwordx4 v[188:191], v2, s[44:47], s82 offen nt
s_add_u32 s82, s82, 4096
v_and_b32_dpp v24, v12, v16 row_newbcast:5 row_mask:0xf bank_mask:0xf
v_and_b32_dpp v25, v12, v17 row_newbcast:5 row_mask:0xf bank_mask:0xf
v_and_b32_dpp v26, v12, v18 row_newbcast:5 row_mask:0xf bank_mask:0xf
v_and_b32_dpp v27, v12, v19 row_newbcast:5 row_mask:0xf bank_mask:0xf
s_nop 1
v_mfma_f32_16x16x32_bf16 v[28:31], v[148:151], v[24:27], v[28:31]
s_waitcnt vmcnt(9)
buffer_load_dwordx4 v[64:67], v2, s[44:47], s82 offen nt
s_add_u32 s82, s82, 4096
v_and_b32_dpp v20, v12, v16 row_newbcast:6 row_mask:0xf bank_mask:0xf
v_and_b32_dpp v21, v12, v17 row_newbcast:6 row_mask:0xf bank_mask:0xf
v_and_b32_dpp v22, v12, v18 row_newbcast:6 row_mask:0xf bank_mask:0xf
v_and_b32_dpp v23, v12, v19 row_newbcast:6 row_mask:0xf bank_mask:0xf
s_nop 1
v_mfma_f32_16x16x32_bf16 v[28:31], v[152:155], v[20:23], v[28:31]
s_waitcnt vmcnt(9)
buffer_load_dwordx4 v[68:71], v2, s[44:47], s82 offen nt
s_add_u32 s82, s82, 4096
v_and_b32_dpp v24, v12, v16 row_newbcast:7 row_mask:0xf bank_mask:0xf
v_and_b32_dpp v25, v12, v17 row_newbcast:7 row_mask:0xf bank_mask:0xf
v_and_b32_dpp v26, v12, v18 row_newbcast:7 row_mask:0xf bank_mask:0xf
v_and_b32_dpp v27, v12, v19 row_newbcast:7 row_mask:0xf bank_mask:0xf
s_nop 1
v_mfma_f32_16x16x32_bf16 v[28:31], v[156:159], v[24:27], v[28:31]
s_waitcnt vmcnt(9)
buffer_load_dwordx4 v[72:75], v2, s[44:47], s82 offen nt
s_add_u32 s82, s82, 4096
v_and_b32_dpp v20, v12, v16 row_newbcast:8 row_mask:0xf bank_mask:0xf
v_and_b32_dpp v21, v12, v17 row_newbcast:8 row_mask:0xf bank_mask:0xf
v_and_b32_dpp v22, v12, v18 row_newbcast:8 row_mask:0xf bank_mask:0xf
v_and_b32_dpp v23, v12, v19 row_newbcast:8 row_mask:0xf bank_mask:0xf
s_nop 1
v_mfma_f32_16x16x32_bf16 v[28:31], v[160:163], v[20:23], v[28:31]
s_waitcnt vmcnt(9)
buffer_load_dwordx4 v[76:79], v2, s[44:47], s82 offen nt
s_add_u32 s82, s82, 4096
v_and_b32_dpp v24, v12, v16 row_newbcast:9 row_mask:0xf bank_mask:0xf
v_and_b32_dpp v25, v12, v17 row_newbcast:9 row_mask:0xf bank_mask:0xf
v_and_b32_dpp v26, v12, v18 row_newbcast:9 row_mask:0xf bank_mask:0xf
v_and_b32_dpp v27, v12, v19 row_newbcast:9 row_mask:0xf bank_mask:0xf
s_nop 1
v_mfma_f32_16x16x32_bf16 v[28:31], v[164:167], v[24:27], v[28:31]
s_waitcnt vmcnt(9)
buffer_load_dwordx4 v[80:83], v2, s[44:47], s82 offen nt
s_add_u32 s82, s82, 4096
v_and_b32_dpp v20, v12, v16 row_newbcast:10 row_mask:0xf bank_mask:0xf
v_and_b32_dpp v21, v12, v17 row_newbcast:10 row_mask:0xf bank_mask:0xf
v_and_b32_dpp v22, v12, v18 row_newbcast:10 row_mask:0xf bank_mask:0xf
v_and_b32_dpp v23, v12, v19 row_newbcast:10 row_mask:0xf bank_mask:0xf
s_nop 1
v_mfma_f32_16x16x32_bf16 v[28:31], v[168:171], v[20:23], v[28:31]
s_waitcnt vmcnt(9)
buffer_load_dwordx4 v[84:87], v2, s[44:47], s82 offen nt
s_add_u32 s82, s82, 4096
v_and_b32_dpp v24, v12, v16 row_newbcast:11 row_mask:0xf bank_mask:0xf
v_and_b32_dpp v25, v12, v17 row_newbcast:11 row_mask:0xf bank_mask:0xf
v_and_b32_dpp v26, v12, v18 row_newbcast:11 row_mask:0xf bank_mask:0xf
v_and_b32_dpp v27, v12, v19 row_newbcast:11 row_mask:0xf bank_mask:0xf
s_nop 1
v_mfma_f32_16x16x32_bf16 v[28:31], v[172:175], v[24:27], v[28:31]
s_waitcnt vmcnt(9)
buffer_load_dwordx4 v[88:91], v2, s[44:47], s82 offen nt
s_add_u32 s82, s82, 4096
v_and_b32_dpp v20, v12, v16 row_newbcast:12 row_mask:0xf bank_mask:0xf
v_and_b32_dpp v21, v12, v17 row_newbcast:12 row_mask:0xf bank_mask:0xf
v_and_b32_dpp v22, v12, v18 row_newbcast:12 row_mask:0xf bank_mask:0xf
v_and_b32_dpp v23, v12, v19 row_newbcast:12 row_mask:0xf bank_mask:0xf
s_nop 1
v_mfma_f32_16x16x32_bf16 v[28:31], v[176:179], v[20:23], v[28:31]
s_waitcnt vmcnt(9)
buffer_load_dwordx4 v[92:95], v2, s[44:47], s82 offen nt
s_add_u32 s82, s82, 4096
v_and_b32_dpp v24, v12, v16 row_newbcast:13 row_mask:0xf bank_mask:0xf
v_and_b32_dpp v25, v12, v17 row_newbcast:13 row_mask:0xf bank_mask:0xf
v_and_b32_dpp v26, v12, v18 row_newbcast:13 row_mask:0xf bank_mask:0xf
v_and_b32_dpp v27, v12, v19 row_newbcast:13 row_mask:0xf bank_mask:0xf
s_nop 1
v_mfma_f32_16x16x32_bf16 v[28:31], v[180:183], v[24:27], v[28:31]
s_waitcnt vmcnt(9)
buffer_load_dwordx4 v[96:99], v2, s[44:47], s82 offen nt
s_add_u32 s82, s82, 4096
v_and_b32_dpp v20, v12, v16 row_newbcast:14 row_mask:0xf bank_mask:0xf
v_and_b32_dpp v21, v12, v17 row_newbcast:14 row_mask:0xf bank_mask:0xf
v_and_b32_dpp v22, v12, v18 row_newbcast:14 row_mask:0xf bank_mask:0xf
v_and_b32_dpp v23, v12, v19 row_newbcast:14 row_mask:0xf bank_mask:0xf
s_nop 1
v_mfma_f32_16x16x32_bf16 v[28:31], v[184:187], v[20:23], v[28:31]
s_waitcnt vmcnt(9)
buffer_load_dwordx4 v[100:103], v2, s[44:47], s82 offen nt
s_add_u32 s82, s82, 4096
v_and_b32_dpp v24, v12, v16 row_newbcast:15 row_mask:0xf bank_mask:0xf
v_and_b32_dpp v25, v12, v17 row_newbcast:15 row_mask:0xf bank_mask:0xf
v_and_b32_dpp v26, v12, v18 row_newbcast:15 row_mask:0xf bank_mask:0xf
v_and_b32_dpp v27, v12, v19 row_newbcast:15 row_mask:0xf bank_mask:0xf
s_nop 1
v_mfma_f32_16x16x32_bf16 v[28:31], v[188:191], v[24:27], v[28:31]
v_add_u32 v202, 1, v202
s_cmp_eq_u32 s75, 0
s_cbranch_scc0 L151
ds_write_b32 v203, v202
L151:
s_waitcnt lgkmcnt(0)
v_mov_b32 v12, v13
s_waitcnt lgkmcnt(0)
v_readfirstlane_b32 s3, v200
ds_read_b32 v200, v201
ds_read_b32 v13, v14
v_add_u32 v14, 256, v14
s_waitcnt vmcnt(9)
buffer_load_dwordx4 v[104:107], v2, s[44:47], s82 offen nt
s_add_u32 s82, s82, 4096
v_and_b32_dpp v20, v12, v16 row_newbcast:0 row_mask:0xf bank_mask:0xf
v_and_b32_dpp v21, v12, v17 row_newbcast:0 row_mask:0xf bank_mask:0xf
v_and_b32_dpp v22, v12, v18 row_newbcast:0 row_mask:0xf bank_mask:0xf
v_and_b32_dpp v23, v12, v19 row_newbcast:0 row_mask:0xf bank_mask:0xf
s_nop 1
v_mfma_f32_16x16x32_bf16 v[28:31], v[64:67], v[20:23], v[28:31]
s_waitcnt vmcnt(9)
buffer_load_dwordx4 v[108:111], v2, s[44:47], s82 offen nt
s_add_u32 s82, s82, 4096
v_and_b32_dpp v24, v12, v16 row_newbcast:1 row_mask:0xf bank_mask:0xf
v_and_b32_dpp v25, v12, v17 row_newbcast:1 row_mask:0xf bank_mask:0xf
v_and_b32_dpp v26, v12, v18 row_newbcast:1 row_mask:0xf bank_mask:0xf
v_and_b32_dpp v27, v12, v19 row_newbcast:1 row_mask:0xf bank_mask:0xf
s_nop 1
v_mfma_f32_16x16x32_bf16 v[28:31], v[68:71], v[24:27], v[28:31]
s_waitcnt vmcnt(9)
buffer_load_dwordx4 v[112:115], v2, s[44:47], s82 offen nt
s_add_u32 s82, s82, 4096
v_and_b32_dpp v20, v12, v16 row_newbcast:2 row_mask:0xf bank_mask:0xf
v_and_b32_dpp v21, v12, v17 row_newbcast:2 row_mask:0xf bank_mask:0xf
v_and_b32_dpp v22, v12, v18 row_newbcast:2 row_mask:0xf bank_mask:0xf
v_and_b32_dpp v23, v12, v19 row_newbcast:2 row_mask:0xf bank_mask:0xf
s_nop 1
v_mfma_f32_16x16x32_bf16 v[28:31], v[72:75], v[20:23], v[28:31]
s_waitcnt vmcnt(9)
buffer_load_dwordx4 v[116:119], v2, s[44:47], s82 offen nt
s_add_u32 s82, s82, 4096
v_and_b32_dpp v24, v12, v16 row_newbcast:3 row_mask:0xf bank_mask:0xf
v_and_b32_dpp v25, v12, v17 row_newbcast:3 row_mask:0xf bank_mask:0xf
v_and_b32_dpp v26, v12, v18 row_newbcast:3 row_mask:0xf bank_mask:0xf
v_and_b32_dpp v27, v12, v19 row_newbcast:3 row_mask:0xf bank_mask:0xf
s_nop 1
v_mfma_f32_16x16x32_bf16 v[28:31], v[76:79], v[24:27], v[28:31]
s_waitcnt vmcnt(9)
buffer_load_dwordx4 v[120:123], v2, s[44:47], s82 offen nt
s_add_u32 s82, s82, 4096
v_and_b32_dpp v20, v12, v16 row_newbcast:4 row_mask:0xf bank_mask:0xf
v_and_b32_dpp v21, v12, v17 row_newbcast:4 row_mask:0xf bank_mask:0xf
v_and_b32_dpp v22, v12, v18 row_newbcast:4 row_mask:0xf bank_mask:0xf
v_and_b32_dpp v23, v12, v19 row_newbcast:4 row_mask:0xf bank_mask:0xf
s_nop 1
v_mfma_f32_16x16x32_bf16 v[28:31], v[80:83], v[20:23], v[28:31]
s_waitcnt vmcnt(9)
buffer_load_dwordx4 v[124:127], v2, s[44:47], s82 offen nt
s_add_u32 s82, s82, 4096
v_and_b32_dpp v24, v12, v16 row_newbcast:5 row_mask:0xf bank_mask:0xf
v_and_b32_dpp v25, v12, v17 row_newbcast:5 row_mask:0xf bank_mask:0xf
v_and_b32_dpp v26, v12, v18 row_newbcast:5 row_mask:0xf bank_mask:0xf
v_and_b32_dpp v27, v12, v19 row_newbcast:5 row_mask:0xf bank_mask:0xf
s_nop 1
v_mfma_f32_16x16x32_bf16 v[28:31], v[84:87], v[24:27], v[28:31]
s_waitcnt vmcnt(9)
buffer_load_dwordx4 v[128:131], v2, s[44:47], s82 offen nt
s_add_u32 s82, s82, 4096
v_and_b32_dpp v20, v12, v16 row_newbcast:6 row_mask:0xf bank_mask:0xf
v_and_b32_dpp v21, v12, v17 row_newbcast:6 row_mask:0xf bank_mask:0xf
v_and_b32_dpp v22, v12, v18 row_newbcast:6 row_mask:0xf bank_mask:0xf
v_and_b32_dpp v23, v12, v19 row_newbcast:6 row_mask:0xf bank_mask:0xf
s_nop 1
v_mfma_f32_16x16x32_bf16 v[28:31], v[88:91], v[20:23], v[28:31]
s_waitcnt vmcnt(9)
buffer_load_dwordx4 v[132:135], v2, s[44:47], s82 offen nt
s_add_u32 s82, s82, 4096
v_and_b32_dpp v24, v12, v16 row_newbcast:7 row_mask:0xf bank_mask:0xf
v_and_b32_dpp v25, v12, v17 row_newbcast:7 row_mask:0xf bank_mask:0xf
v_and_b32_dpp v26, v12, v18 row_newbcast:7 row_mask:0xf bank_mask:0xf
v_and_b32_dpp v27, v12, v19 row_newbcast:7 row_mask:0xf bank_mask:0xf
s_nop 1
v_mfma_f32_16x16x32_bf16 v[28:31], v[92:95], v[24:27], v[28:31]
s_waitcnt vmcnt(9)
buffer_load_dwordx4 v[136:139], v2, s[44:47], s82 offen nt
s_add_u32 s82, s82, 4096
v_and_b32_dpp v20, v12, v16 row_newbcast:8 row_mask:0xf bank_mask:0xf
v_and_b32_dpp v21, v12, v17 row_newbcast:8 row_mask:0xf bank_mask:0xf
v_and_b32_dpp v22, v12, v18 row_newbcast:8 row_mask:0xf bank_mask:0xf
v_and_b32_dpp v23, v12, v19 row_newbcast:8 row_mask:0xf bank_mask:0xf
s_nop 1
v_mfma_f32_16x16x32_bf16 v[28:31], v[96:99], v[20:23], v[28:31]
s_waitcnt vmcnt(9)
buffer_load_dwordx4 v[140:143], v2, s[44:47], s82 offen nt
s_add_u32 s82, s82, 4096
v_and_b32_dpp v24, v12, v16 row_newbcast:9 row_mask:0xf bank_mask:0xf
v_and_b32_dpp v25, v12, v17 row_newbcast:9 row_mask:0xf bank_mask:0xf
v_and_b32_dpp v26, v12, v18 row_newbcast:9 row_mask:0xf bank_mask:0xf
v_and_b32_dpp v27, v12, v19 row_newbcast:9 row_mask:0xf bank_mask:0xf
s_nop 1
v_mfma_f32_16x16x32_bf16 v[28:31], v[100:103], v[24:27], v[28:31]
s_waitcnt vmcnt(9)
buffer_load_dwordx4 v[144:147], v2, s[44:47], s82 offen nt
s_add_u32 s82, s82, 4096
v_and_b32_dpp v20, v12, v16 row_newbcast:10 row_mask:0xf bank_mask:0xf
v_and_b32_dpp v21, v12, v17 row_newbcast:10 row_mask:0xf bank_mask:0xf
v_and_b32_dpp v22, v12, v18 row_newbcast:10 row_mask:0xf bank_mask:0xf
v_and_b32_dpp v23, v12, v19 row_newbcast:10 row_mask:0xf bank_mask:0xf
s_nop 1
v_mfma_f32_16x16x32_bf16 v[28:31], v[104:107], v[20:23], v[28:31]
s_waitcnt vmcnt(9)
buffer_load_dwordx4 v[148:151], v2, s[44:47], s82 offen nt
s_add_u32 s82, s82, 4096
v_and_b32_dpp v24, v12, v16 row_newbcast:11 row_mask:0xf bank_mask:0xf
v_and_b32_dpp v25, v12, v17 row_newbcast:11 row_mask:0xf bank_mask:0xf
v_and_b32_dpp v26, v12, v18 row_newbcast:11 row_mask:0xf bank_mask:0xf
v_and_b32_dpp v27, v12, v19 row_newbcast:11 row_mask:0xf bank_mask:0xf
s_nop 1
v_mfma_f32_16x16x32_bf16 v[28:31], v[108:111], v[24:27], v[28:31]
s_waitcnt vmcnt(9)
buffer_load_dwordx4 v[152:155], v2, s[44:47], s82 offen nt
s_add_u32 s82, s82, 4096
v_and_b32_dpp v20, v12, v16 row_newbcast:12 row_mask:0xf bank_mask:0xf
v_and_b32_dpp v21, v12, v17 row_newbcast:12 row_mask:0xf bank_mask:0xf
v_and_b32_dpp v22, v12, v18 row_newbcast:12 row_mask:0xf bank_mask:0xf
v_and_b32_dpp v23, v12, v19 row_newbcast:12 row_mask:0xf bank_mask:0xf
s_nop 1
v_mfma_f32_16x16x32_bf16 v[28:31], v[112:115], v[20:23], v[28:31]
s_waitcnt vmcnt(9)
buffer_load_dwordx4 v[156:159], v2, s[44:47], s82 offen nt
s_add_u32 s82, s82, 4096
v_and_b32_dpp v24, v12, v16 row_newbcast:13 row_mask:0xf bank_mask:0xf
v_and_b32_dpp v25, v12, v17 row_newbcast:13 row_mask:0xf bank_mask:0xf
v_and_b32_dpp v26, v12, v18 row_newbcast:13 row_mask:0xf bank_mask:0xf
v_and_b32_dpp v27, v12, v19 row_newbcast:13 row_mask:0xf bank_mask:0xf
s_nop 1
v_mfma_f32_16x16x32_bf16 v[28:31], v[116:119], v[24:27], v[28:31]
s_waitcnt vmcnt(9)
buffer_load_dwordx4 v[160:163], v2, s[44:47], s82 offen nt
s_add_u32 s82, s82, 4096
v_and_b32_dpp v20, v12, v16 row_newbcast:14 row_mask:0xf bank_mask:0xf
v_and_b32_dpp v21, v12, v17 row_newbcast:14 row_mask:0xf bank_mask:0xf
v_and_b32_dpp v22, v12, v18 row_newbcast:14 row_mask:0xf bank_mask:0xf
v_and_b32_dpp v23, v12, v19 row_newbcast:14 row_mask:0xf bank_mask:0xf
s_nop 1
v_mfma_f32_16x16x32_bf16 v[28:31], v[120:123], v[20:23], v[28:31]
s_waitcnt vmcnt(9)
buffer_load_dwordx4 v[164:167], v2, s[44:47], s82 offen nt
s_add_u32 s82, s82, 4096
v_and_b32_dpp v24, v12, v16 row_newbcast:15 row_mask:0xf bank_mask:0xf
v_and_b32_dpp v25, v12, v17 row_newbcast:15 row_mask:0xf bank_mask:0xf
v_and_b32_dpp v26, v12, v18 row_newbcast:15 row_mask:0xf bank_mask:0xf
v_and_b32_dpp v27, v12, v19 row_newbcast:15 row_mask:0xf bank_mask:0xf
s_nop 1
v_mfma_f32_16x16x32_bf16 v[28:31], v[124:127], v[24:27], v[28:31]
v_add_u32 v202, 1, v202
s_cmp_eq_u32 s75, 0
s_cbranch_scc0 L152
ds_write_b32 v203, v202
L152:
s_waitcnt lgkmcnt(0)
v_mov_b32 v12, v13
s_waitcnt lgkmcnt(0)
v_readfirstlane_b32 s3, v200
ds_read_b32 v200, v201
s_waitcnt vmcnt(9)
buffer_load_dwordx4 v[168:171], v2, s[44:47], s82 offen nt
s_add_u32 s82, s82, 4096
v_and_b32_dpp v20, v12, v16 row_newbcast:0 row_mask:0xf bank_mask:0xf
v_and_b32_dpp v21, v12, v17 row_newbcast:0 row_mask:0xf bank_mask:0xf
v_and_b32_dpp v22, v12, v18 row_newbcast:0 row_mask:0xf bank_mask:0xf
v_and_b32_dpp v23, v12, v19 row_newbcast:0 row_mask:0xf bank_mask:0xf
s_nop 1
v_mfma_f32_16x16x32_bf16 v[28:31], v[128:131], v[20:23], v[28:31]
s_waitcnt vmcnt(9)
buffer_load_dwordx4 v[172:175], v2, s[44:47], s82 offen nt
s_add_u32 s82, s82, 4096
v_and_b32_dpp v24, v12, v16 row_newbcast:1 row_mask:0xf bank_mask:0xf
v_and_b32_dpp v25, v12, v17 row_newbcast:1 row_mask:0xf bank_mask:0xf
v_and_b32_dpp v26, v12, v18 row_newbcast:1 row_mask:0xf bank_mask:0xf
v_and_b32_dpp v27, v12, v19 row_newbcast:1 row_mask:0xf bank_mask:0xf
s_nop 1
v_mfma_f32_16x16x32_bf16 v[28:31], v[132:135], v[24:27], v[28:31]
s_waitcnt vmcnt(9)
buffer_load_dwordx4 v[176:179], v2, s[44:47], s82 offen nt
s_add_u32 s82, s82, 4096
v_and_b32_dpp v20, v12, v16 row_newbcast:2 row_mask:0xf bank_mask:0xf
v_and_b32_dpp v21, v12, v17 row_newbcast:2 row_mask:0xf bank_mask:0xf
v_and_b32_dpp v22, v12, v18 row_newbcast:2 row_mask:0xf bank_mask:0xf
v_and_b32_dpp v23, v12, v19 row_newbcast:2 row_mask:0xf bank_mask:0xf
s_nop 1
v_mfma_f32_16x16x32_bf16 v[28:31], v[136:139], v[20:23], v[28:31]
s_waitcnt vmcnt(9)
buffer_load_dwordx4 v[180:183], v2, s[44:47], s82 offen nt
s_add_u32 s82, s82, 4096
v_and_b32_dpp v24, v12, v16 row_newbcast:3 row_mask:0xf bank_mask:0xf
v_and_b32_dpp v25, v12, v17 row_newbcast:3 row_mask:0xf bank_mask:0xf
v_and_b32_dpp v26, v12, v18 row_newbcast:3 row_mask:0xf bank_mask:0xf
v_and_b32_dpp v27, v12, v19 row_newbcast:3 row_mask:0xf bank_mask:0xf
s_nop 1
v_mfma_f32_16x16x32_bf16 v[28:31], v[140:143], v[24:27], v[28:31]
s_waitcnt vmcnt(9)
buffer_load_dwordx4 v[184:187], v2, s[44:47], s82 offen nt
s_add_u32 s82, s82, 4096
v_and_b32_dpp v20, v12, v16 row_newbcast:4 row_mask:0xf bank_mask:0xf
v_and_b32_dpp v21, v12, v17 row_newbcast:4 row_mask:0xf bank_mask:0xf
v_and_b32_dpp v22, v12, v18 row_newbcast:4 row_mask:0xf bank_mask:0xf
v_and_b32_dpp v23, v12, v19 row_newbcast:4 row_mask:0xf bank_mask:0xf
s_nop 1
v_mfma_f32_16x16x32_bf16 v[28:31], v[144:147], v[20:23], v[28:31]
s_waitcnt vmcnt(9)
buffer_load_dwordx4 v[188:191], v2, s[44:47], s82 offen nt
s_add_u32 s82, s82, 4096
v_and_b32_dpp v24, v12, v16 row_newbcast:5 row_mask:0xf bank_mask:0xf
v_and_b32_dpp v25, v12, v17 row_newbcast:5 row_mask:0xf bank_mask:0xf
v_and_b32_dpp v26, v12, v18 row_newbcast:5 row_mask:0xf bank_mask:0xf
v_and_b32_dpp v27, v12, v19 row_newbcast:5 row_mask:0xf bank_mask:0xf
s_nop 1
v_mfma_f32_16x16x32_bf16 v[28:31], v[148:151], v[24:27], v[28:31]
s_waitcnt vmcnt(9)
v_and_b32_dpp v20, v12, v16 row_newbcast:6 row_mask:0xf bank_mask:0xf
v_and_b32_dpp v21, v12, v17 row_newbcast:6 row_mask:0xf bank_mask:0xf
v_and_b32_dpp v22, v12, v18 row_newbcast:6 row_mask:0xf bank_mask:0xf
v_and_b32_dpp v23, v12, v19 row_newbcast:6 row_mask:0xf bank_mask:0xf
s_nop 1
v_mfma_f32_16x16x32_bf16 v[28:31], v[152:155], v[20:23], v[28:31]
s_waitcnt vmcnt(8)
v_and_b32_dpp v24, v12, v16 row_newbcast:7 row_mask:0xf bank_mask:0xf
v_and_b32_dpp v25, v12, v17 row_newbcast:7 row_mask:0xf bank_mask:0xf
v_and_b32_dpp v26, v12, v18 row_newbcast:7 row_mask:0xf bank_mask:0xf
v_and_b32_dpp v27, v12, v19 row_newbcast:7 row_mask:0xf bank_mask:0xf
s_nop 1
v_mfma_f32_16x16x32_bf16 v[28:31], v[156:159], v[24:27], v[28:31]
s_waitcnt vmcnt(7)
v_and_b32_dpp v20, v12, v16 row_newbcast:8 row_mask:0xf bank_mask:0xf
v_and_b32_dpp v21, v12, v17 row_newbcast:8 row_mask:0xf bank_mask:0xf
v_and_b32_dpp v22, v12, v18 row_newbcast:8 row_mask:0xf bank_mask:0xf
v_and_b32_dpp v23, v12, v19 row_newbcast:8 row_mask:0xf bank_mask:0xf
s_nop 1
v_mfma_f32_16x16x32_bf16 v[28:31], v[160:163], v[20:23], v[28:31]
s_waitcnt vmcnt(6)
v_and_b32_dpp v24, v12, v16 row_newbcast:9 row_mask:0xf bank_mask:0xf
v_and_b32_dpp v25, v12, v17 row_newbcast:9 row_mask:0xf bank_mask:0xf
v_and_b32_dpp v26, v12, v18 row_newbcast:9 row_mask:0xf bank_mask:0xf
v_and_b32_dpp v27, v12, v19 row_newbcast:9 row_mask:0xf bank_mask:0xf
s_nop 1
v_mfma_f32_16x16x32_bf16 v[28:31], v[164:167], v[24:27], v[28:31]
s_waitcnt vmcnt(5)
v_and_b32_dpp v20, v12, v16 row_newbcast:10 row_mask:0xf bank_mask:0xf
v_and_b32_dpp v21, v12, v17 row_newbcast:10 row_mask:0xf bank_mask:0xf
v_and_b32_dpp v22, v12, v18 row_newbcast:10 row_mask:0xf bank_mask:0xf
v_and_b32_dpp v23, v12, v19 row_newbcast:10 row_mask:0xf bank_mask:0xf
s_nop 1
v_mfma_f32_16x16x32_bf16 v[28:31], v[168:171], v[20:23], v[28:31]
s_waitcnt vmcnt(4)
v_and_b32_dpp v24, v12, v16 row_newbcast:11 row_mask:0xf bank_mask:0xf
v_and_b32_dpp v25, v12, v17 row_newbcast:11 row_mask:0xf bank_mask:0xf
v_and_b32_dpp v26, v12, v18 row_newbcast:11 row_mask:0xf bank_mask:0xf
v_and_b32_dpp v27, v12, v19 row_newbcast:11 row_mask:0xf bank_mask:0xf
s_nop 1
v_mfma_f32_16x16x32_bf16 v[28:31], v[172:175], v[24:27], v[28:31]
s_waitcnt vmcnt(3)
v_and_b32_dpp v20, v12, v16 row_newbcast:12 row_mask:0xf bank_mask:0xf
v_and_b32_dpp v21, v12, v17 row_newbcast:12 row_mask:0xf bank_mask:0xf
v_and_b32_dpp v22, v12, v18 row_newbcast:12 row_mask:0xf bank_mask:0xf
v_and_b32_dpp v23, v12, v19 row_newbcast:12 row_mask:0xf bank_mask:0xf
s_nop 1
v_mfma_f32_16x16x32_bf16 v[28:31], v[176:179], v[20:23], v[28:31]
s_waitcnt vmcnt(2)
v_and_b32_dpp v24, v12, v16 row_newbcast:13 row_mask:0xf bank_mask:0xf
v_and_b32_dpp v25, v12, v17 row_newbcast:13 row_mask:0xf bank_mask:0xf
v_and_b32_dpp v26, v12, v18 row_newbcast:13 row_mask:0xf bank_mask:0xf
v_and_b32_dpp v27, v12, v19 row_newbcast:13 row_mask:0xf bank_mask:0xf
s_nop 1
v_mfma_f32_16x16x32_bf16 v[28:31], v[180:183], v[24:27], v[28:31]
s_waitcnt vmcnt(1)
v_and_b32_dpp v20, v12, v16 row_newbcast:14 row_mask:0xf bank_mask:0xf
v_and_b32_dpp v21, v12, v17 row_newbcast:14 row_mask:0xf bank_mask:0xf
v_and_b32_dpp v22, v12, v18 row_newbcast:14 row_mask:0xf bank_mask:0xf
v_and_b32_dpp v23, v12, v19 row_newbcast:14 row_mask:0xf bank_mask:0xf
s_nop 1
v_mfma_f32_16x16x32_bf16 v[28:31], v[184:187], v[20:23], v[28:31]
s_waitcnt vmcnt(0)
v_and_b32_dpp v24, v12, v16 row_newbcast:15 row_mask:0xf bank_mask:0xf
v_and_b32_dpp v25, v12, v17 row_newbcast:15 row_mask:0xf bank_mask:0xf
v_and_b32_dpp v26, v12, v18 row_newbcast:15 row_mask:0xf bank_mask:0xf
v_and_b32_dpp v27, v12, v19 row_newbcast:15 row_mask:0xf bank_mask:0xf
s_nop 1
v_mfma_f32_16x16x32_bf16 v[28:31], v[188:191], v[24:27], v[28:31]
v_add_u32 v202, 1, v202
s_cmp_eq_u32 s75, 0
s_cbranch_scc0 L153
ds_write_b32 v203, v202
L153:
v_lshrrev_b32 v6, 4, v1
v_lshlrev_b32 v6, 7, v6
v_and_b32 v7, 15, v1
v_lshlrev_b32 v7, 2, v7
v_add_u32 v6, v6, v7
s_lshl_b32 s76, s75, 9
s_add_u32 s76, s76, 151552
v_add_u32 v6, s76, v6
s_mov_b64 exec, s[94:95]
ds_write_b32 v6, v28
ds_write_b32 v6, v29 offset:32
ds_write_b32 v6, v30 offset:64
ds_write_b32 v6, v31 offset:96
s_mov_b64 exec, -1
s_waitcnt lgkmcnt(0)
L_join3:
s_barrier
s_cmp_eq_u32 s72, 0
s_cbranch_scc0 L154
v_lshlrev_b32 v4, 3, v1
v_add_u32 v4, 151552, v4
ds_read_b64 v[8:9], v4
ds_read_b64 v[10:11], v4 offset:512
ds_read_b64 v[12:13], v4 offset:1024
ds_read_b64 v[14:15], v4 offset:1536
s_lshl_b32 s76, s74, 13
s_lshl_b32 s77, s73, 8
s_add_u32 s76, s76, s77
s_add_u32 s76, s76, 1048576
s_waitcnt lgkmcnt(0)
v_pk_add_f32 v[8:9], v[8:9], v[10:11]
v_pk_add_f32 v[12:13], v[12:13], v[14:15]
v_pk_add_f32 v[8:9], v[8:9], v[12:13]
v_cvt_pk_bf16_f32 v8, v8, v9
v_min_u32 v8, -2, v8
s_nop 1
v_mov_b32_dpp v9, v8 quad_perm:[1,1,1,1] row_mask:0xf bank_mask:0xf
v_mov_b32_dpp v10, v8 quad_perm:[2,2,2,2] row_mask:0xf bank_mask:0xf
v_mov_b32_dpp v11, v8 quad_perm:[3,3,3,3] row_mask:0xf bank_mask:0xf
s_mov_b64 exec, s[64:65]
buffer_store_dwordx4 v[8:11], v3, s[60:63], s76 offen sc0 sc1
s_mov_b64 exec, -1
L154:
s_barrier
s_cmp_lt_u32 s72, 4
s_cbranch_scc1 L155
s_cmp_ge_u32 s54, s85
s_cbranch_scc1 L155
s_mov_b32 s77, s52
s_mov_b32 s78, s53
s_mov_b32 s79, s54
s_mov_b32 s76, s55
v_mov_b32 v4, v204
s_cmp_eq_u32 s86, 2
s_cbranch_scc1 L157
L156:
s_mov_b32 m0, s78
s_waitcnt vmcnt(5)
buffer_load_dwordx4 v4, s[56:59], s77 offen nt lds
s_add_u32 s77, s77, s76
s_add_u32 s78, s78, 4096
s_add_u32 s79, s79, 1
s_cmp_eq_u32 s79, s100
s_cselect_b32 s80, s101, 0
s_add_u32 s77, s77, s80
s_cmp_lt_u32 s79, s85
s_cbranch_scc1 L156
s_branch L155
L157:
s_mov_b32 m0, s78
s_waitcnt vmcnt(2)
buffer_load_dwordx4 v4, s[56:59], s77 offen nt lds
s_add_u32 s77, s77, s76
s_add_u32 s78, s78, 4096
s_add_u32 s79, s79, 1
s_cmp_eq_u32 s79, s100
s_cselect_b32 s80, s101, 0
s_add_u32 s77, s77, s80
s_cmp_lt_u32 s79, s85
s_cbranch_scc1 L157
L155:
s_cmp_eq_u32 s86, 0
s_cbranch_scc1 L_roleO
s_cmp_eq_u32 s86, 1
s_cbranch_scc1 L_roleG
s_cmp_eq_u32 s86, 2
s_cbranch_scc1 L_roleD
s_branch L_roleF
L_roleO:
s_lshr_b32 s85, s73, 1
s_and_b32 s84, s73, 1
s_lshl_b32 s76, s74, 1
s_add_u32 s84, s84, s76
v_and_b32 v4, 15, v1
v_lshlrev_b32 v4, 13, v4
v_lshrrev_b32 v5, 4, v1
v_lshlrev_b32 v5, 4, v5
v_add_u32 v16, v4, v5
s_lshl_b32 s100, s85, 11
s_lshl_b32 s77, s72, 8
s_add_u32 s100, s100, s77
s_add_u32 s100, s100, 1048576
s_mov_b64 exec, s[94:95]
buffer_load_dwordx4 v[32:35], v16, s[60:63], s100 offen offset:0 sc1
buffer_load_dwordx4 v[36:39], v16, s[60:63], s100 offen offset:64 sc1
buffer_load_dwordx4 v[40:43], v16, s[60:63], s100 offen offset:128 sc1
buffer_load_dwordx4 v[44:47], v16, s[60:63], s100 offen offset:192 sc1
s_mov_b64 exec, -1
v_and_b32 v4, 31, v1
v_lshlrev_b32 v4, 5, v4
s_lshl_b32 s81, s74, 2
s_add_u32 s81, s81, 155648
v_add_u32 v4, s81, v4
ds_read_b32 v5, v4
s_waitcnt lgkmcnt(0)
v_readfirstlane_b32 s87, v5
s_nop 1
v_cmp_ne_u32 vcc, s87, v5
s_nop 0
s_cmp_eq_u64 vcc, 0
s_cselect_b32 s87, 1, 0
s_mov_b32 s48, s16
s_mov_b32 s49, s17
s_mov_b32 s50, 16384
s_mov_b32 s51, 0x20000
v_bfe_u32 v14, v1, 4, 1
v_lshlrev_b32 v14, 11, v14
v_and_b32 v15, 15, v1
v_lshlrev_b32 v13, 3, v15
v_add_u32 v13, v13, v14
s_lshl_b32 s76, s84, 7
s_lshl_b32 s77, s85, 12
s_add_u32 s76, s76, s77
buffer_load_dwordx2 v[28:29], v13, s[48:51], s76 offen
s_add_u32 s82, s76, 1245184
v_lshrrev_b32 v15, 1, v15
v_lshlrev_b32 v15, 4, v15
v_add_u32 v14, v14, v15
v_lshrrev_b32 v4, 4, v1
v_and_b32 v5, 15, v1
v_lshrrev_b32 v6, 2, v5
v_and_b32 v5, 3, v5
v_lshrrev_b32 v7, 1, v6
v_and_b32 v8, 1, v4
v_lshlrev_b32 v8, 1, v8
v_or_b32 v7, v7, v8
v_lshlrev_b32 v8, 3, v4
v_add_u32 v8, v8, v6
v_lshlrev_b32 v8, 7, v8
v_lshlrev_b32 v5, 3, v5
v_add_u32 v8, v8, v5
s_lshl_b32 s76, s72, 14
v_add_u32 v8, s76, v8
v_xor_b32 v9, 0, v7
v_lshlrev_b32 v9, 5, v9
v_add_u32 v9, v9, v8
v_xor_b32 v10, 1, v7
v_lshlrev_b32 v10, 5, v10
v_add_u32 v10, v10, v8
v_xor_b32 v11, 2, v7
v_lshlrev_b32 v11, 5, v11
v_add_u32 v11, v11, v8
v_xor_b32 v12, 3, v7
v_lshlrev_b32 v12, 5, v12
v_add_u32 v12, v12, v8
ds_read_b64_tr_b16 v[64:65], v9 offset:0
ds_read_b64_tr_b16 v[66:67], v9 offset:512
ds_read_b64_tr_b16 v[68:69], v10 offset:0
ds_read_b64_tr_b16 v[70:71], v10 offset:512
ds_read_b64_tr_b16 v[72:73], v11 offset:0
ds_read_b64_tr_b16 v[74:75], v11 offset:512
ds_read_b64_tr_b16 v[76:77], v12 offset:0
ds_read_b64_tr_b16 v[78:79], v12 offset:512
ds_read_b64_tr_b16 v[80:81], v9 offset:4096
ds_read_b64_tr_b16 v[82:83], v9 offset:4608
ds_read_b64_tr_b16 v[84:85], v10 offset:4096
ds_read_b64_tr_b16 v[86:87], v10 offset:4608
ds_read_b64_tr_b16 v[88:89], v11 offset:4096
ds_read_b64_tr_b16 v[90:91], v11 offset:4608
ds_read_b64_tr_b16 v[92:93], v12 offset:4096
ds_read_b64_tr_b16 v[94:95], v12 offset:4608
ds_read_b64_tr_b16 v[96:97], v9 offset:8192
ds_read_b64_tr_b16 v[98:99], v9 offset:8704
ds_read_b64_tr_b16 v[100:101], v10 offset:8192
ds_read_b64_tr_b16 v[102:103], v10 offset:8704
ds_read_b64_tr_b16 v[104:105], v11 offset:8192
ds_read_b64_tr_b16 v[106:107], v11 offset:8704
ds_read_b64_tr_b16 v[108:109], v12 offset:8192
ds_read_b64_tr_b16 v[110:111], v12 offset:8704
ds_read_b64_tr_b16 v[112:113], v9 offset:12288
ds_read_b64_tr_b16 v[114:115], v9 offset:12800
ds_read_b64_tr_b16 v[116:117], v10 offset:12288
ds_read_b64_tr_b16 v[118:119], v10 offset:12800
ds_read_b64_tr_b16 v[120:121], v11 offset:12288
ds_read_b64_tr_b16 v[122:123], v11 offset:12800
ds_read_b64_tr_b16 v[124:125], v12 offset:12288
ds_read_b64_tr_b16 v[126:127], v12 offset:12800
v_and_b32 v4, 15, v1
v_lshrrev_b32 v5, 4, v1
s_lshl_b32 s76, s72, 11
s_add_u32 s76, s76, 131072
v_lshlrev_b32 v6, 8, v4
v_add_u32 v6, s76, v6
v_add_u32 v7, 0, v5
v_xor_b32 v7, v7, v4
v_lshlrev_b32 v7, 4, v7
v_add_u32 v240, v7, v6
v_add_u32 v7, 4, v5
v_xor_b32 v7, v7, v4
v_lshlrev_b32 v7, 4, v7
v_add_u32 v241, v7, v6
v_add_u32 v7, 8, v5
v_xor_b32 v7, v7, v4
v_lshlrev_b32 v7, 4, v7
v_add_u32 v242, v7, v6
v_add_u32 v7, 12, v5
v_xor_b32 v7, v7, v4
v_lshlrev_b32 v7, 4, v7
v_add_u32 v243, v7, v6
v_lshrrev_b32 v4, 2, v1
v_xor_b32 v4, s72, v4
v_lshlrev_b32 v4, 4, v4
v_and_b32 v5, 3, v1
v_lshlrev_b32 v5, 2, v5
v_add_u32 v4, v4, v5
s_lshl_b32 s76, s72, 8
s_add_u32 s76, s76, 131072
v_add_u32 v244, s76, v4
v_bfe_u32 v4, v1, 4, 1
s_lshl_b32 s76, s72, 1
v_add_u32 v4, s76, v4
v_and_b32 v5, 15, v1
v_xor_b32 v5, v5, v4
v_lshlrev_b32 v5, 4, v5
v_lshlrev_b32 v4, 8, v4
v_add_u32 v4, v4, v5
v_lshrrev_b32 v5, 5, v1
v_lshlrev_b32 v5, 13, v5
v_add_u32 v4, v4, v5
v_add_u32 v19, 131072, v4
v_and_b32 v4, 31, v1
v_lshlrev_b32 v13, 4, v4
s_lshl_b32 s78, s84, 13
s_add_u32 s78, s78, 1114112
s_lshl_b32 s77, s72, 11
s_add_u32 s79, s78, s77
s_lshl_b32 s77, s85, 9
s_add_u32 s79, s79, s77
s_lshl_b32 s77, s85, 11
s_add_u32 s78, s78, s77
s_mov_b64 exec, s[94:95]
s_mov_b32 s83, 0
s_branch L160
L158:
buffer_load_dwordx4 v[32:35], v16, s[60:63], s100 offen offset:0 sc1
buffer_load_dwordx4 v[36:39], v16, s[60:63], s100 offen offset:64 sc1
buffer_load_dwordx4 v[40:43], v16, s[60:63], s100 offen offset:128 sc1
buffer_load_dwordx4 v[44:47], v16, s[60:63], s100 offen offset:192 sc1
s_sleep 1
L160:
s_waitcnt vmcnt(0)
v_max3_u32 v17, v32, v33, v34
v_max3_u32 v17, v17, v35, v36
v_max3_u32 v17, v17, v37, v38
v_max3_u32 v17, v17, v39, v40
v_max3_u32 v17, v17, v41, v42
v_max3_u32 v17, v17, v43, v44
v_max3_u32 v17, v17, v45, v46
v_max_u32 v17, v17, v47
v_cmp_eq_u32 vcc, -1, v17
s_cbranch_vccz L159
s_mov_b64 exec, vcc
s_add_u32 s83, s83, 1
s_cmp_gt_u32 s83, 1048576
s_cbranch_scc0 L158
L159:
s_mov_b64 exec, -1
s_waitcnt lgkmcnt(0)
v_mfma_f32_16x16x32_bf16 v[48:51], v[64:67], v[32:35], 0
v_mfma_f32_16x16x32_bf16 v[52:55], v[68:71], v[32:35], 0
v_mfma_f32_16x16x32_bf16 v[56:59], v[72:75], v[32:35], 0
v_mfma_f32_16x16x32_bf16 v[60:63], v[76:79], v[32:35], 0
v_mfma_f32_16x16x32_bf16 v[48:51], v[80:83], v[36:39], v[48:51]
v_mfma_f32_16x16x32_bf16 v[52:55], v[84:87], v[36:39], v[52:55]
v_mfma_f32_16x16x32_bf16 v[56:59], v[88:91], v[36:39], v[56:59]
v_mfma_f32_16x16x32_bf16 v[60:63], v[92:95], v[36:39], v[60:63]
v_mfma_f32_16x16x32_bf16 v[48:51], v[96:99], v[40:43], v[48:51]
v_mfma_f32_16x16x32_bf16 v[52:55], v[100:103], v[40:43], v[52:55]
v_mfma_f32_16x16x32_bf16 v[56:59], v[104:107], v[40:43], v[56:59]
v_mfma_f32_16x16x32_bf16 v[60:63], v[108:111], v[40:43], v[60:63]
v_mfma_f32_16x16x32_bf16 v[48:51], v[112:115], v[44:47], v[48:51]
v_mfma_f32_16x16x32_bf16 v[52:55], v[116:119], v[44:47], v[52:55]
v_mfma_f32_16x16x32_bf16 v[56:59], v[120:123], v[44:47], v[56:59]
v_mfma_f32_16x16x32_bf16 v[60:63], v[124:127], v[44:47], v[60:63]
s_mov_b64 exec, s[94:95]
s_nop 3
ds_write_b128 v240, v[48:51]
ds_write_b128 v241, v[52:55]
ds_write_b128 v242, v[56:59]
ds_write_b128 v243, v[60:63]
s_mov_b64 exec, -1
s_waitcnt lgkmcnt(0)
s_barrier
s_cmp_ge_u32 s72, 4
s_cbranch_scc1 L161
ds_read_b128 v[32:35], v19 offset:0
ds_read_b128 v[36:39], v19 offset:2048
ds_read_b128 v[40:43], v19 offset:4096
ds_read_b128 v[44:47], v19 offset:6144
s_waitcnt lgkmcnt(0)
v_pk_add_f32 v[32:33], v[32:33], v[36:37]
v_pk_add_f32 v[40:41], v[40:41], v[44:45]
v_pk_add_f32 v[34:35], v[34:35], v[38:39]
v_pk_add_f32 v[42:43], v[42:43], v[46:47]
v_pk_add_f32 v[32:33], v[32:33], v[40:41]
v_pk_add_f32 v[34:35], v[34:35], v[42:43]
v_mov_b32 v36, v32
v_mov_b32 v37, v33
v_mov_b32 v38, v34
v_mov_b32 v39, v35
v_permlane32_swap_b32 v32, v36
v_permlane32_swap_b32 v33, v37
v_permlane32_swap_b32 v34, v38
v_permlane32_swap_b32 v35, v39
v_pk_add_f32 v[32:33], v[32:33], v[36:37]
v_pk_add_f32 v[34:35], v[34:35], v[38:39]
v_min_u32 v32, -2, v32
v_min_u32 v33, -2, v33
v_min_u32 v34, -2, v34
v_min_u32 v35, -2, v35
s_mov_b64 exec, 0xffffffff
s_cmp_eq_u32 s87, 1
s_cbranch_scc1 L162
buffer_store_dwordx4 v[32:35], v13, s[60:63], s79 offen sc0 sc1
s_branch L163
L162:
buffer_store_dwordx4 v[32:35], v13, s[60:63], s79 offen
L163:
s_mov_b64 exec, -1
s_branch L_end
L161:
s_cmp_eq_u32 s72, 4
s_cbranch_scc0 L_end
v_lshlrev_b32 v20, 16, v28
v_and_b32 v21, 0xffff0000, v28
v_lshlrev_b32 v22, 16, v29
v_and_b32 v23, 0xffff0000, v29
s_mov_b32 s83, 0
L164:
buffer_load_dwordx4 v[32:35], v2, s[60:63], s78 offen sc1
buffer_load_dwordx4 v[36:39], v2, s[60:63], s78 offen offset:1024 sc1
L166:
s_waitcnt vmcnt(0)
v_max3_u32 v17, v32, v33, v34
v_max3_u32 v17, v17, v35, v36
v_max3_u32 v17, v17, v37, v38
v_max_u32 v17, v17, v39
v_cmp_eq_u32 vcc, -1, v17
s_cbranch_vccz L165
s_mov_b64 exec, vcc
s_add_u32 s83, s83, 1
s_cmp_gt_u32 s83, 1048576
s_cbranch_scc0 L164
L165:
s_mov_b64 exec, -1
v_pk_add_f32 v[40:41], v[32:33], v[36:37]
v_pk_add_f32 v[42:43], v[34:35], v[38:39]
v_mov_b32 v44, v40
v_mov_b32 v45, v41
v_mov_b32 v46, v42
v_mov_b32 v47, v43
v_permlane32_swap_b32 v40, v44
v_permlane32_swap_b32 v41, v45
v_permlane32_swap_b32 v42, v46
v_permlane32_swap_b32 v43, v47
v_pk_add_f32 v[40:41], v[40:41], v[44:45]
v_pk_add_f32 v[42:43], v[42:43], v[46:47]
v_cvt_pk_bf16_f32 v44, v40, v41
v_cvt_pk_bf16_f32 v45, v42, v43
v_lshlrev_b32 v40, 16, v44
v_and_b32 v41, 0xffff0000, v44
v_lshlrev_b32 v42, 16, v45
v_and_b32 v43, 0xffff0000, v45
v_pk_add_f32 v[40:41], v[40:41], v[20:21]
v_pk_add_f32 v[42:43], v[42:43], v[22:23]
v_cvt_pk_bf16_f32 v48, v40, v41
v_cvt_pk_bf16_f32 v49, v42, v43
v_min_u32 v48, -2, v48
v_min_u32 v49, -2, v49
s_nop 0
v_mov_b32_dpp v50, v48 quad_perm:[1,1,3,3] row_mask:0xf bank_mask:0xf
v_mov_b32_dpp v51, v49 quad_perm:[1,1,3,3] row_mask:0xf bank_mask:0xf
s_mov_b64 exec, 0x55555555
buffer_store_dwordx4 v[48:51], v14, s[60:63], s82 offen sc0 sc1
s_mov_b64 exec, -1
s_branch L_end
L_roleG:
v_and_b32 v4, 31, v1
v_lshlrev_b32 v4, 5, v4
s_lshl_b32 s81, s74, 2
s_add_u32 s81, s81, 155648
v_add_u32 v4, s81, v4
ds_read_b32 v5, v4
s_waitcnt lgkmcnt(0)
v_readfirstlane_b32 s87, v5
s_nop 1
v_cmp_ne_u32 vcc, s87, v5
s_nop 0
s_cmp_eq_u64 vcc, 0
s_cselect_b32 s87, 1, 0
v_and_b32 v4, 15, v1
v_lshrrev_b32 v5, 4, v1
s_lshl_b32 s76, s72, 11
s_add_u32 s76, s76, 131072
v_lshlrev_b32 v6, 8, v4
v_add_u32 v6, s76, v6
v_add_u32 v7, 0, v5
v_xor_b32 v7, v7, v4
v_lshlrev_b32 v7, 4, v7
v_add_u32 v240, v7, v6
v_add_u32 v7, 4, v5
v_xor_b32 v7, v7, v4
v_lshlrev_b32 v7, 4, v7
v_add_u32 v241, v7, v6
v_add_u32 v7, 8, v5
v_xor_b32 v7, v7, v4
v_lshlrev_b32 v7, 4, v7
v_add_u32 v242, v7, v6
v_add_u32 v7, 12, v5
v_xor_b32 v7, v7, v4
v_lshlrev_b32 v7, 4, v7
v_add_u32 v243, v7, v6
v_lshrrev_b32 v4, 2, v1
v_xor_b32 v4, s72, v4
v_lshlrev_b32 v4, 4, v4
v_and_b32 v5, 3, v1
v_lshlrev_b32 v5, 2, v5
v_add_u32 v4, v4, v5
s_lshl_b32 s76, s72, 8
s_add_u32 s76, s76, 131072
v_add_u32 v244, s76, v4
s_lshl_b32 s76, s72, 1
v_xor_b32 v14, s76, v1
v_lshlrev_b32 v14, 4, v14
s_lshl_b32 s76, s72, 11
s_add_u32 s76, s76, 147456
v_add_u32 v14, s76, v14
v_and_b32 v17, 7, v1
v_lshrrev_b32 v18, 4, v1
v_lshlrev_b32 v19, 11, v17
s_lshl_b32 s76, s72, 8
s_add_u32 s76, s76, 147456
v_add_u32 v19, s76, v19
v_lshlrev_b32 v17, 1, v17
v_add_u32 v28, 0, v18
v_xor_b32 v28, v28, v17
v_lshlrev_b32 v28, 4, v28
v_add_u32 v232, v28, v19
v_add_u32 v28, 4, v18
v_xor_b32 v28, v28, v17
v_lshlrev_b32 v28, 4, v28
v_add_u32 v233, v28, v19
v_add_u32 v28, 8, v18
v_xor_b32 v28, v28, v17
v_lshlrev_b32 v28, 4, v28
v_add_u32 v234, v28, v19
v_add_u32 v28, 12, v18
v_xor_b32 v28, v28, v17
v_lshlrev_b32 v28, 4, v28
v_add_u32 v235, v28, v19
s_sub_u32 s76, s73, 8
s_and_b32 s77, s76, 1
s_mul_i32 s77, s77, 57344
s_lshr_b32 s76, s76, 1
s_mul_i32 s78, s74, 7
s_add_u32 s76, s76, s78
s_lshl_b32 s76, s76, 7
s_add_u32 s76, s76, s77
s_mul_i32 s77, s72, 7168
s_add_u32 s76, s76, s77
s_add_u32 s82, s76, 1261568
v_lshlrev_b32 v15, 1, v1
s_lshl_b32 s76, s72, 13
s_add_u32 s76, s76, 1048576
v_lshlrev_b32 v17, 8, v1
s_mov_b64 s[96:97], 0xffffffff
s_cmp_eq_u32 s72, 0
s_cbranch_scc0 L168
v_and_b32 v18, 3, v1
v_lshlrev_b32 v18, 12, v18
v_lshlrev_b32 v17, 8, v1
v_add_u32 v17, v17, v18
v_add_u32 v17, 1245312, v17
s_mov_b32 s83, 0
s_mov_b64 exec, 0xff
L167:
buffer_load_dword v18, v17, s[60:63], 0 offen sc1
s_waitcnt vmcnt(0)
v_cmp_ne_u32 vcc, -1, v18
s_cbranch_vccnz L168
s_add_u32 s83, s83, 1
s_cmp_gt_u32 s83, 4000
s_cbranch_scc1 L168
s_sleep 2
s_branch L167
L168:
s_mov_b64 exec, -1
s_waitcnt vmcnt(0)
s_barrier
s_lshl_b32 s100, s72, 11
s_add_u32 s100, s100, 1245184
buffer_load_dwordx4 v[20:23], v2, s[60:63], s100 offen sc1
buffer_load_dwordx4 v[24:27], v2, s[60:63], s100 offen offset:1024 sc1
v_lshrrev_b32 v4, 4, v1
v_and_b32 v5, 15, v1
v_lshrrev_b32 v6, 2, v5
v_and_b32 v5, 3, v5
v_lshrrev_b32 v7, 1, v6
v_and_b32 v8, 1, v4
v_lshlrev_b32 v8, 1, v8
v_or_b32 v7, v7, v8
v_lshlrev_b32 v8, 3, v4
v_add_u32 v8, v8, v6
v_lshlrev_b32 v8, 7, v8
v_lshlrev_b32 v5, 3, v5
v_add_u32 v8, v8, v5
s_lshl_b32 s76, s72, 14
v_add_u32 v8, s76, v8
v_xor_b32 v9, 0, v7
v_lshlrev_b32 v9, 5, v9
v_add_u32 v9, v9, v8
v_xor_b32 v10, 1, v7
v_lshlrev_b32 v10, 5, v10
v_add_u32 v10, v10, v8
v_xor_b32 v11, 2, v7
v_lshlrev_b32 v11, 5, v11
v_add_u32 v11, v11, v8
v_xor_b32 v12, 3, v7
v_lshlrev_b32 v12, 5, v12
v_add_u32 v12, v12, v8
ds_read_b64_tr_b16 v[160:161], v9 offset:0
ds_read_b64_tr_b16 v[162:163], v9 offset:512
ds_read_b64_tr_b16 v[164:165], v10 offset:0
ds_read_b64_tr_b16 v[166:167], v10 offset:512
ds_read_b64_tr_b16 v[168:169], v11 offset:0
ds_read_b64_tr_b16 v[170:171], v11 offset:512
ds_read_b64_tr_b16 v[172:173], v12 offset:0
ds_read_b64_tr_b16 v[174:175], v12 offset:512
ds_read_b64_tr_b16 v[176:177], v9 offset:4096
ds_read_b64_tr_b16 v[178:179], v9 offset:4608
ds_read_b64_tr_b16 v[180:181], v10 offset:4096
ds_read_b64_tr_b16 v[182:183], v10 offset:4608
ds_read_b64_tr_b16 v[184:185], v11 offset:4096
ds_read_b64_tr_b16 v[186:187], v11 offset:4608
ds_read_b64_tr_b16 v[188:189], v12 offset:4096
ds_read_b64_tr_b16 v[190:191], v12 offset:4608
ds_read_b64_tr_b16 v[192:193], v9 offset:8192
ds_read_b64_tr_b16 v[194:195], v9 offset:8704
ds_read_b64_tr_b16 v[196:197], v10 offset:8192
ds_read_b64_tr_b16 v[198:199], v10 offset:8704
ds_read_b64_tr_b16 v[200:201], v11 offset:8192
ds_read_b64_tr_b16 v[202:203], v11 offset:8704
ds_read_b64_tr_b16 v[204:205], v12 offset:8192
ds_read_b64_tr_b16 v[206:207], v12 offset:8704
ds_read_b64_tr_b16 v[208:209], v9 offset:12288
ds_read_b64_tr_b16 v[210:211], v9 offset:12800
ds_read_b64_tr_b16 v[212:213], v10 offset:12288
ds_read_b64_tr_b16 v[214:215], v10 offset:12800
ds_read_b64_tr_b16 v[216:217], v11 offset:12288
ds_read_b64_tr_b16 v[218:219], v11 offset:12800
ds_read_b64_tr_b16 v[220:221], v12 offset:12288
ds_read_b64_tr_b16 v[222:223], v12 offset:12800
s_mov_b32 s83, 0
s_branch L171
L169:
buffer_load_dwordx4 v[20:23], v2, s[60:63], s100 offen sc1
buffer_load_dwordx4 v[24:27], v2, s[60:63], s100 offen offset:1024 sc1
s_sleep 1
L171:
s_waitcnt vmcnt(0)
v_max3_u32 v17, v20, v21, v22
v_max3_u32 v17, v17, v23, v24
v_max3_u32 v17, v17, v25, v26
v_max_u32 v17, v17, v27
v_cmp_eq_u32 vcc, -1, v17
s_cbranch_vccz L170
s_mov_b64 exec, vcc
s_add_u32 s83, s83, 1
s_cmp_gt_u32 s83, 1048576
s_cbranch_scc0 L169
L170:
s_mov_b64 exec, -1
v_lshlrev_b32 v96, 16, v20
v_and_b32 v97, 0xffff0000, v20
v_lshlrev_b32 v98, 16, v21
v_and_b32 v99, 0xffff0000, v21
v_lshlrev_b32 v100, 16, v22
v_and_b32 v101, 0xffff0000, v22
v_lshlrev_b32 v102, 16, v23
v_and_b32 v103, 0xffff0000, v23
v_lshlrev_b32 v104, 16, v24
v_and_b32 v105, 0xffff0000, v24
v_lshlrev_b32 v106, 16, v25
v_and_b32 v107, 0xffff0000, v25
v_lshlrev_b32 v108, 16, v26
v_and_b32 v109, 0xffff0000, v26
v_lshlrev_b32 v110, 16, v27
v_and_b32 v111, 0xffff0000, v27
v_readfirstlane_b32 s80, v96
s_nop 1
v_pk_add_f32 v[128:129], v[96:97], s[80:81] op_sel_hi:[1,0] neg_lo:[0,1] neg_hi:[0,1]
v_pk_add_f32 v[130:131], v[98:99], s[80:81] op_sel_hi:[1,0] neg_lo:[0,1] neg_hi:[0,1]
v_pk_add_f32 v[132:133], v[100:101], s[80:81] op_sel_hi:[1,0] neg_lo:[0,1] neg_hi:[0,1]
v_pk_add_f32 v[134:135], v[102:103], s[80:81] op_sel_hi:[1,0] neg_lo:[0,1] neg_hi:[0,1]
v_pk_add_f32 v[136:137], v[104:105], s[80:81] op_sel_hi:[1,0] neg_lo:[0,1] neg_hi:[0,1]
v_pk_add_f32 v[138:139], v[106:107], s[80:81] op_sel_hi:[1,0] neg_lo:[0,1] neg_hi:[0,1]
v_pk_add_f32 v[140:141], v[108:109], s[80:81] op_sel_hi:[1,0] neg_lo:[0,1] neg_hi:[0,1]
v_pk_add_f32 v[142:143], v[110:111], s[80:81] op_sel_hi:[1,0] neg_lo:[0,1] neg_hi:[0,1]
v_pk_add_f32 v[144:145], v[128:129], v[130:131]
v_pk_mul_f32 v[146:147], v[128:129], v[128:129]
v_pk_fma_f32 v[146:147], v[130:131], v[130:131], v[146:147]
v_pk_add_f32 v[144:145], v[144:145], v[132:133]
v_pk_fma_f32 v[146:147], v[132:133], v[132:133], v[146:147]
v_pk_add_f32 v[144:145], v[144:145], v[134:135]
v_pk_fma_f32 v[146:147], v[134:135], v[134:135], v[146:147]
v_pk_add_f32 v[144:145], v[144:145], v[136:137]
v_pk_fma_f32 v[146:147], v[136:137], v[136:137], v[146:147]
v_pk_add_f32 v[144:145], v[144:145], v[138:139]
v_pk_fma_f32 v[146:147], v[138:139], v[138:139], v[146:147]
v_pk_add_f32 v[144:145], v[144:145], v[140:141]
v_pk_fma_f32 v[146:147], v[140:141], v[140:141], v[146:147]
v_pk_add_f32 v[144:145], v[144:145], v[142:143]
v_pk_fma_f32 v[146:147], v[142:143], v[142:143], v[146:147]
v_add_f32 v144, v144, v145
v_add_f32 v146, v146, v147
s_nop 0
v_add_f32_dpp v144, v144, v144 row_ror:8 row_mask:0xf bank_mask:0xf
v_add_f32_dpp v146, v146, v146 row_ror:8 row_mask:0xf bank_mask:0xf
s_nop 0
v_add_f32_dpp v144, v144, v144 row_ror:4 row_mask:0xf bank_mask:0xf
v_add_f32_dpp v146, v146, v146 row_ror:4 row_mask:0xf bank_mask:0xf
s_nop 0
v_add_f32_dpp v144, v144, v144 row_ror:2 row_mask:0xf bank_mask:0xf
v_add_f32_dpp v146, v146, v146 row_ror:2 row_mask:0xf bank_mask:0xf
s_nop 0
v_add_f32_dpp v144, v144, v144 row_ror:1 row_mask:0xf bank_mask:0xf
v_add_f32_dpp v146, v146, v146 row_ror:1 row_mask:0xf bank_mask:0xf
v_mov_b32 v148, v144
v_mov_b32 v149, v146
s_nop 0
v_permlane16_swap_b32 v144, v148
v_permlane16_swap_b32 v146, v149
v_add_f32 v144, v144, v148
v_add_f32 v146, v146, v149
v_mov_b32 v148, v144
v_mov_b32 v149, v146
s_nop 0
v_permlane32_swap_b32 v144, v148
v_permlane32_swap_b32 v146, v149
v_add_f32 v144, v144, v148
v_add_f32 v146, v146, v149
v_mul_f32 v144, 0x3a800000, v144
v_mul_f32 v146, 0x3a800000, v146
v_add_f32 v150, s80, v144
v_fma_f32 v152, -v144, v144, v146
v_max_f32 v152, 0, v152
v_cvt_pk_bf16_f32 v150, v150, v152
v_and_b32 v152, 0xffff0000, v150
v_lshlrev_b32 v150, 16, v150
v_add_f32 v152, 0x3727c5ac, v152
v_cvt_pk_bf16_f32 v152, v152, v152
v_lshlrev_b32 v152, 16, v152
v_sqrt_f32 v152, v152
s_nop 0
v_cvt_pk_bf16_f32 v152, v152, v152
v_lshlrev_b32 v152, 16, v152
v_rcp_f32 v152, v152
v_pk_add_f32 v[154:155], v[96:97], v[150:151] op_sel_hi:[1,0] neg_lo:[0,1] neg_hi:[0,1]
v_cvt_pk_bf16_f32 v154, v154, v155
v_and_b32 v155, 0xffff0000, v154
v_lshlrev_b32 v154, 16, v154
v_pk_mul_f32 v[154:155], v[154:155], v[152:153] op_sel_hi:[1,0]
v_cvt_pk_bf16_f32 v48, v154, v155
v_pk_add_f32 v[156:157], v[98:99], v[150:151] op_sel_hi:[1,0] neg_lo:[0,1] neg_hi:[0,1]
v_cvt_pk_bf16_f32 v156, v156, v157
v_and_b32 v157, 0xffff0000, v156
v_lshlrev_b32 v156, 16, v156
v_pk_mul_f32 v[156:157], v[156:157], v[152:153] op_sel_hi:[1,0]
v_cvt_pk_bf16_f32 v49, v156, v157
v_pk_add_f32 v[154:155], v[100:101], v[150:151] op_sel_hi:[1,0] neg_lo:[0,1] neg_hi:[0,1]
v_cvt_pk_bf16_f32 v154, v154, v155
v_and_b32 v155, 0xffff0000, v154
v_lshlrev_b32 v154, 16, v154
v_pk_mul_f32 v[154:155], v[154:155], v[152:153] op_sel_hi:[1,0]
v_cvt_pk_bf16_f32 v50, v154, v155
v_pk_add_f32 v[156:157], v[102:103], v[150:151] op_sel_hi:[1,0] neg_lo:[0,1] neg_hi:[0,1]
v_cvt_pk_bf16_f32 v156, v156, v157
v_and_b32 v157, 0xffff0000, v156
v_lshlrev_b32 v156, 16, v156
v_pk_mul_f32 v[156:157], v[156:157], v[152:153] op_sel_hi:[1,0]
v_cvt_pk_bf16_f32 v51, v156, v157
v_pk_add_f32 v[154:155], v[104:105], v[150:151] op_sel_hi:[1,0] neg_lo:[0,1] neg_hi:[0,1]
v_cvt_pk_bf16_f32 v154, v154, v155
v_and_b32 v155, 0xffff0000, v154
v_lshlrev_b32 v154, 16, v154
v_pk_mul_f32 v[154:155], v[154:155], v[152:153] op_sel_hi:[1,0]
v_cvt_pk_bf16_f32 v52, v154, v155
v_pk_add_f32 v[156:157], v[106:107], v[150:151] op_sel_hi:[1,0] neg_lo:[0,1] neg_hi:[0,1]
v_cvt_pk_bf16_f32 v156, v156, v157
v_and_b32 v157, 0xffff0000, v156
v_lshlrev_b32 v156, 16, v156
v_pk_mul_f32 v[156:157], v[156:157], v[152:153] op_sel_hi:[1,0]
v_cvt_pk_bf16_f32 v53, v156, v157
v_pk_add_f32 v[154:155], v[108:109], v[150:151] op_sel_hi:[1,0] neg_lo:[0,1] neg_hi:[0,1]
v_cvt_pk_bf16_f32 v154, v154, v155
v_and_b32 v155, 0xffff0000, v154
v_lshlrev_b32 v154, 16, v154
v_pk_mul_f32 v[154:155], v[154:155], v[152:153] op_sel_hi:[1,0]
v_cvt_pk_bf16_f32 v54, v154, v155
v_pk_add_f32 v[156:157], v[110:111], v[150:151] op_sel_hi:[1,0] neg_lo:[0,1] neg_hi:[0,1]
v_cvt_pk_bf16_f32 v156, v156, v157
v_and_b32 v157, 0xffff0000, v156
v_lshlrev_b32 v156, 16, v156
v_pk_mul_f32 v[156:157], v[156:157], v[152:153] op_sel_hi:[1,0]
v_cvt_pk_bf16_f32 v55, v156, v157
ds_write_b128 v14, v[48:51]
ds_write_b128 v14, v[52:55] offset:1024
s_waitcnt lgkmcnt(0)
s_barrier
ds_read_b128 v[32:35], v232
ds_read_b128 v[36:39], v233
ds_read_b128 v[40:43], v234
ds_read_b128 v[44:47], v235
s_waitcnt lgkmcnt(0)
v_mfma_f32_16x16x32_bf16 v[48:51], v[160:163], v[32:35], 0
v_mfma_f32_16x16x32_bf16 v[52:55], v[164:167], v[32:35], 0
v_mfma_f32_16x16x32_bf16 v[56:59], v[168:171], v[32:35], 0
v_mfma_f32_16x16x32_bf16 v[60:63], v[172:175], v[32:35], 0
v_mfma_f32_16x16x32_bf16 v[48:51], v[176:179], v[36:39], v[48:51]
v_mfma_f32_16x16x32_bf16 v[52:55], v[180:183], v[36:39], v[52:55]
v_mfma_f32_16x16x32_bf16 v[56:59], v[184:187], v[36:39], v[56:59]
v_mfma_f32_16x16x32_bf16 v[60:63], v[188:191], v[36:39], v[60:63]
v_mfma_f32_16x16x32_bf16 v[48:51], v[192:195], v[40:43], v[48:51]
v_mfma_f32_16x16x32_bf16 v[52:55], v[196:199], v[40:43], v[52:55]
v_mfma_f32_16x16x32_bf16 v[56:59], v[200:203], v[40:43], v[56:59]
v_mfma_f32_16x16x32_bf16 v[60:63], v[204:207], v[40:43], v[60:63]
v_mfma_f32_16x16x32_bf16 v[48:51], v[208:211], v[44:47], v[48:51]
v_mfma_f32_16x16x32_bf16 v[52:55], v[212:215], v[44:47], v[52:55]
v_mfma_f32_16x16x32_bf16 v[56:59], v[216:219], v[44:47], v[56:59]
v_mfma_f32_16x16x32_bf16 v[60:63], v[220:223], v[44:47], v[60:63]
s_mov_b64 exec, s[94:95]
s_nop 3
ds_write_b128 v240, v[48:51]
ds_write_b128 v241, v[52:55]
ds_write_b128 v242, v[56:59]
ds_write_b128 v243, v[60:63]
s_mov_b64 exec, -1
s_waitcnt lgkmcnt(0)
s_waitcnt vmcnt(0)
s_barrier
ds_read_b32 v20, v244 offset:0
ds_read_b32 v21, v244 offset:2048
ds_read_b32 v22, v244 offset:4096
ds_read_b32 v23, v244 offset:6144
ds_read_b32 v24, v244 offset:8192
ds_read_b32 v25, v244 offset:10240
ds_read_b32 v26, v244 offset:12288
ds_read_b32 v27, v244 offset:14336
s_waitcnt lgkmcnt(0)
v_add_f32 v20, v20, v21
v_add_f32 v22, v22, v23
v_add_f32 v24, v24, v25
v_add_f32 v26, v26, v27
v_add_f32 v20, v20, v22
v_add_f32 v24, v24, v26
v_add_f32 v20, v20, v24
v_cvt_pk_bf16_f32 v20, v20, v20
v_lshlrev_b32 v20, 16, v20
s_bitcmp1_b32 s73, 0
s_cbranch_scc1 L172
v_mul_f32 v17, v20, v20
v_mul_f32 v18, v17, v20
v_mul_f32 v18, 0x3d372713, v18
v_add_f32 v18, v20, v18
v_mul_f32 v18, 0x3f4c422a, v18
v_mul_f32 v18, 0x4038aa3b, v18
v_min_f32 v18, 0x42700000, v18
v_exp_f32 v18, v18
s_nop 0
v_add_f32 v19, 1.0, v18
v_rcp_f32 v19, v19
s_nop 0
v_mul_f32 v18, v18, v19
v_mul_f32 v20, v20, v18
L172:
s_nop 1
v_mov_b32_dpp v17, v20 quad_perm:[1,1,3,3] row_mask:0xf bank_mask:0xf
v_cvt_pk_bf16_f32 v20, v20, v17
v_min_u32 v20, -2, v20
s_nop 1
v_mov_b32_dpp v21, v20 row_shl:2 row_mask:0xf bank_mask:0xf
v_mov_b32_dpp v22, v20 row_shl:4 row_mask:0xf bank_mask:0xf
v_mov_b32_dpp v23, v20 row_shl:6 row_mask:0xf bank_mask:0xf
s_mov_b64 exec, s[66:67]
s_cmp_eq_u32 s87, 1
s_cbranch_scc1 L173
buffer_store_dwordx4 v[20:23], v15, s[60:63], s82 offen sc0 sc1
s_branch L174
L173:
buffer_store_dwordx4 v[20:23], v15, s[60:63], s82 offen
L174:
s_mov_b64 exec, -1
s_branch L_end
L_roleD:
v_lshrrev_b32 v4, 1, v1
v_xor_b32 v4, s72, v4
v_lshlrev_b32 v4, 4, v4
v_and_b32 v5, 1, v1
v_lshlrev_b32 v5, 3, v5
v_add_u32 v4, v4, v5
s_lshl_b32 s76, s72, 9
s_add_u32 s76, s76, 131072
v_add_u32 v232, s76, v4
s_lshl_b32 s76, s74, 15
s_lshl_b32 s77, s72, 12
s_add_u32 s76, s76, s77
s_sub_u32 s77, s73, 22
s_lshl_b32 s77, s77, 9
s_add_u32 s76, s76, s77
s_add_u32 s82, s76, 1376256
v_lshlrev_b32 v15, 3, v1
s_cmp_eq_u32 s72, 7
s_cbranch_scc0 L176
s_waitcnt vmcnt(0)
s_barrier
s_branch L175
L176:
v_lshrrev_b32 v4, 4, v1
v_and_b32 v5, 15, v1
v_lshrrev_b32 v6, 2, v5
v_and_b32 v5, 3, v5
v_lshrrev_b32 v7, 1, v6
v_and_b32 v8, 1, v4
v_lshlrev_b32 v8, 1, v8
v_or_b32 v7, v7, v8
v_lshlrev_b32 v8, 3, v4
v_add_u32 v8, v8, v6
v_lshlrev_b32 v8, 7, v8
v_lshlrev_b32 v5, 3, v5
v_add_u32 v8, v8, v5
s_lshl_b32 s76, s72, 13
v_add_u32 v8, s76, v8
v_xor_b32 v9, 0, v7
v_lshlrev_b32 v9, 5, v9
v_add_u32 v9, v9, v8
v_xor_b32 v10, 1, v7
v_lshlrev_b32 v10, 5, v10
v_add_u32 v10, v10, v8
v_xor_b32 v11, 2, v7
v_lshlrev_b32 v11, 5, v11
v_add_u32 v11, v11, v8
v_xor_b32 v12, 3, v7
v_lshlrev_b32 v12, 5, v12
v_add_u32 v12, v12, v8
v_and_b32 v4, 15, v1
v_lshrrev_b32 v5, 4, v1
s_lshl_b32 s76, s72, 12
s_add_u32 s76, s76, 131072
v_lshlrev_b32 v6, 9, v4
v_add_u32 v6, s76, v6
v_add_u32 v7, 0, v5
v_xor_b32 v7, v7, v4
v_lshlrev_b32 v7, 4, v7
v_add_u32 v224, v7, v6
v_add_u32 v7, 4, v5
v_xor_b32 v7, v7, v4
v_lshlrev_b32 v7, 4, v7
v_add_u32 v225, v7, v6
v_add_u32 v7, 8, v5
v_xor_b32 v7, v7, v4
v_lshlrev_b32 v7, 4, v7
v_add_u32 v226, v7, v6
v_add_u32 v7, 12, v5
v_xor_b32 v7, v7, v4
v_lshlrev_b32 v7, 4, v7
v_add_u32 v227, v7, v6
v_add_u32 v7, 16, v5
v_xor_b32 v7, v7, v4
v_lshlrev_b32 v7, 4, v7
v_add_u32 v228, v7, v6
v_add_u32 v7, 20, v5
v_xor_b32 v7, v7, v4
v_lshlrev_b32 v7, 4, v7
v_add_u32 v229, v7, v6
v_add_u32 v7, 24, v5
v_xor_b32 v7, v7, v4
v_lshlrev_b32 v7, 4, v7
v_add_u32 v230, v7, v6
v_add_u32 v7, 28, v5
v_xor_b32 v7, v7, v4
v_lshlrev_b32 v7, 4, v7
v_add_u32 v231, v7, v6
v_and_b32 v4, 7, v1
v_mul_u32_u24 v4, 7168, v4
v_bfe_u32 v5, v1, 3, 1
v_lshlrev_b32 v5, 6, v5
v_add_u32 v4, v4, v5
v_lshrrev_b32 v5, 4, v1
v_lshlrev_b32 v5, 4, v5
v_add_u32 v16, v4, v5
s_mul_i32 s76, s74, 7
s_add_u32 s76, s76, s72
s_lshl_b32 s76, s76, 7
s_add_u32 s76, s76, 1261568
s_add_u32 s77, s76, 57344
s_lshl_b32 s78, s72, 11
s_add_u32 s78, s78, 1245184
v_lshlrev_b32 v17, 5, v1
s_mov_b32 s78, s76
s_mov_b32 s79, s77
s_cmp_eq_u32 s72, 0
s_cbranch_scc0 L178
v_and_b32 v18, 3, v1
v_lshlrev_b32 v18, 12, v18
v_lshlrev_b32 v17, 8, v1
v_add_u32 v17, v17, v18
v_add_u32 v17, 1245312, v17
s_mov_b32 s83, 0
s_mov_b64 exec, 0xff
L177:
buffer_load_dword v18, v17, s[60:63], 0 offen sc1
s_waitcnt vmcnt(0)
v_cmp_eq_u32 vcc, -1, v18
s_cbranch_vccz L178
s_add_u32 s83, s83, 1
s_cmp_gt_u32 s83, 4000
s_cbranch_scc1 L178
s_sleep 2
s_branch L177
L178:
s_mov_b64 exec, -1
s_waitcnt vmcnt(0)
s_barrier
buffer_load_dwordx4 v[32:35], v16, s[60:63], s78 offen sc1
buffer_load_dwordx4 v[36:39], v16, s[60:63], s79 offen sc1
ds_read_b64_tr_b16 v[160:161], v9 offset:0
ds_read_b64_tr_b16 v[162:163], v9 offset:512
ds_read_b64_tr_b16 v[164:165], v10 offset:0
ds_read_b64_tr_b16 v[166:167], v10 offset:512
ds_read_b64_tr_b16 v[168:169], v11 offset:0
ds_read_b64_tr_b16 v[170:171], v11 offset:512
ds_read_b64_tr_b16 v[172:173], v12 offset:0
ds_read_b64_tr_b16 v[174:175], v12 offset:512
ds_read_b64_tr_b16 v[176:177], v9 offset:57344
ds_read_b64_tr_b16 v[178:179], v9 offset:57856
ds_read_b64_tr_b16 v[180:181], v10 offset:57344
ds_read_b64_tr_b16 v[182:183], v10 offset:57856
ds_read_b64_tr_b16 v[184:185], v11 offset:57344
ds_read_b64_tr_b16 v[186:187], v11 offset:57856
ds_read_b64_tr_b16 v[188:189], v12 offset:57344
ds_read_b64_tr_b16 v[190:191], v12 offset:57856
ds_read_b64_tr_b16 v[192:193], v9 offset:4096
ds_read_b64_tr_b16 v[194:195], v9 offset:4608
ds_read_b64_tr_b16 v[196:197], v10 offset:4096
ds_read_b64_tr_b16 v[198:199], v10 offset:4608
ds_read_b64_tr_b16 v[200:201], v11 offset:4096
ds_read_b64_tr_b16 v[202:203], v11 offset:4608
ds_read_b64_tr_b16 v[204:205], v12 offset:4096
ds_read_b64_tr_b16 v[206:207], v12 offset:4608
ds_read_b64_tr_b16 v[208:209], v9 offset:61440
ds_read_b64_tr_b16 v[210:211], v9 offset:61952
ds_read_b64_tr_b16 v[212:213], v10 offset:61440
ds_read_b64_tr_b16 v[214:215], v10 offset:61952
ds_read_b64_tr_b16 v[216:217], v11 offset:61440
ds_read_b64_tr_b16 v[218:219], v11 offset:61952
ds_read_b64_tr_b16 v[220:221], v12 offset:61440
ds_read_b64_tr_b16 v[222:223], v12 offset:61952
s_mov_b32 s83, 0
s_branch L181
L179:
buffer_load_dwordx4 v[32:35], v16, s[60:63], s78 offen sc1
buffer_load_dwordx4 v[36:39], v16, s[60:63], s79 offen sc1
L181:
s_waitcnt vmcnt(0)
v_max3_u32 v17, v32, v33, v34
v_max3_u32 v17, v17, v35, v36
v_max3_u32 v17, v17, v37, v38
v_max_u32 v17, v17, v39
v_cmp_eq_u32 vcc, -1, v17
s_cbranch_vccz L180
s_mov_b64 exec, vcc
s_add_u32 s83, s83, 1
s_cmp_gt_u32 s83, 1048576
s_cbranch_scc0 L179
L180:
s_mov_b64 exec, -1
v_lshlrev_b32 v64, 16, v32
v_and_b32 v65, 0xffff0000, v32
v_lshlrev_b32 v66, 16, v36
v_and_b32 v67, 0xffff0000, v36
v_lshlrev_b32 v68, 16, v33
v_and_b32 v69, 0xffff0000, v33
v_lshlrev_b32 v70, 16, v37
v_and_b32 v71, 0xffff0000, v37
v_pk_mul_f32 v[64:65], v[64:65], v[66:67]
v_pk_mul_f32 v[68:69], v[68:69], v[70:71]
v_cvt_pk_bf16_f32 v72, v64, v65
v_cvt_pk_bf16_f32 v73, v68, v69
v_lshlrev_b32 v64, 16, v34
v_and_b32 v65, 0xffff0000, v34
v_lshlrev_b32 v66, 16, v38
v_and_b32 v67, 0xffff0000, v38
v_lshlrev_b32 v68, 16, v35
v_and_b32 v69, 0xffff0000, v35
v_lshlrev_b32 v70, 16, v39
v_and_b32 v71, 0xffff0000, v39
v_pk_mul_f32 v[64:65], v[64:65], v[66:67]
v_pk_mul_f32 v[68:69], v[68:69], v[70:71]
v_cvt_pk_bf16_f32 v74, v64, v65
v_cvt_pk_bf16_f32 v75, v68, v69
v_mov_b32_dpp v76, v72 row_shl:8 row_mask:0xf bank_mask:0xf
v_mov_b32_dpp v77, v73 row_shl:8 row_mask:0xf bank_mask:0xf
v_mov_b32_dpp v78, v74 row_shl:8 row_mask:0xf bank_mask:0xf
v_mov_b32_dpp v79, v75 row_shl:8 row_mask:0xf bank_mask:0xf
s_waitcnt lgkmcnt(0)
v_mfma_f32_16x16x32_bf16 v[88:91], v[160:163], v[72:75], 0
v_mfma_f32_16x16x32_bf16 v[92:95], v[164:167], v[72:75], 0
v_mfma_f32_16x16x32_bf16 v[96:99], v[168:171], v[72:75], 0
v_mfma_f32_16x16x32_bf16 v[100:103], v[172:175], v[72:75], 0
v_mfma_f32_16x16x32_bf16 v[104:107], v[176:179], v[72:75], 0
v_mfma_f32_16x16x32_bf16 v[108:111], v[180:183], v[72:75], 0
v_mfma_f32_16x16x32_bf16 v[112:115], v[184:187], v[72:75], 0
v_mfma_f32_16x16x32_bf16 v[116:119], v[188:191], v[72:75], 0
v_mfma_f32_16x16x32_bf16 v[88:91], v[192:195], v[76:79], v[88:91]
v_mfma_f32_16x16x32_bf16 v[92:95], v[196:199], v[76:79], v[92:95]
v_mfma_f32_16x16x32_bf16 v[96:99], v[200:203], v[76:79], v[96:99]
v_mfma_f32_16x16x32_bf16 v[100:103], v[204:207], v[76:79], v[100:103]
v_mfma_f32_16x16x32_bf16 v[104:107], v[208:211], v[76:79], v[104:107]
v_mfma_f32_16x16x32_bf16 v[108:111], v[212:215], v[76:79], v[108:111]
v_mfma_f32_16x16x32_bf16 v[112:115], v[216:219], v[76:79], v[112:115]
v_mfma_f32_16x16x32_bf16 v[116:119], v[220:223], v[76:79], v[116:119]
s_mov_b64 exec, s[94:95]
ds_write_b128 v224, v[88:91]
ds_write_b128 v225, v[92:95]
ds_write_b128 v226, v[96:99]
ds_write_b128 v227, v[100:103]
ds_write_b128 v228, v[104:107]
ds_write_b128 v229, v[108:111]
ds_write_b128 v230, v[112:115]
ds_write_b128 v231, v[116:119]
s_mov_b64 exec, -1
s_waitcnt lgkmcnt(0)
L175:
s_barrier
ds_read_b64 v[20:21], v232 offset:0
ds_read_b64 v[22:23], v232 offset:4096
ds_read_b64 v[24:25], v232 offset:8192
ds_read_b64 v[26:27], v232 offset:12288
ds_read_b64 v[28:29], v232 offset:16384
ds_read_b64 v[30:31], v232 offset:20480
ds_read_b64 v[32:33], v232 offset:24576
s_waitcnt lgkmcnt(0)
v_pk_add_f32 v[20:21], v[20:21], v[22:23]
v_pk_add_f32 v[24:25], v[24:25], v[26:27]
v_pk_add_f32 v[28:29], v[28:29], v[30:31]
v_pk_add_f32 v[20:21], v[20:21], v[24:25]
v_pk_add_f32 v[28:29], v[28:29], v[32:33]
v_pk_add_f32 v[20:21], v[20:21], v[28:29]
v_min_u32 v20, -2, v20
v_min_u32 v21, -2, v21
s_nop 0
v_mov_b32_dpp v22, v20 quad_perm:[1,1,3,3] row_mask:0xf bank_mask:0xf
v_mov_b32_dpp v23, v21 quad_perm:[1,1,3,3] row_mask:0xf bank_mask:0xf
s_mov_b32 s78, 0x55555555
s_mov_b32 s79, 0x55555555
s_mov_b64 exec, s[78:79]
buffer_store_dwordx4 v[20:23], v15, s[60:63], s82 offen sc0 sc1
s_mov_b64 exec, -1
s_branch L_end
L_roleF:
s_mov_b32 s68, s34
s_mov_b32 s69, s35
s_mov_b32 s70, 16384
s_mov_b32 s71, 0x20000
s_sub_u32 s78, s73, 30
s_lshl_b32 s76, s74, 1
s_add_u32 s78, s78, s76
v_lshrrev_b32 v4, 4, v1
v_lshlrev_b32 v4, 15, v4
v_and_b32 v5, 15, v1
v_lshlrev_b32 v6, 4, v5
v_add_u32 v16, v4, v6
v_lshlrev_b32 v15, 3, v5
s_lshl_b32 s76, s72, 12
s_lshl_b32 s77, s78, 8
s_add_u32 s76, s76, s77
s_add_u32 s76, s76, 1376256
s_add_u32 s77, s76, 131072
s_lshl_b32 s84, s72, 11
s_lshl_b32 s79, s78, 7
s_add_u32 s84, s84, s79
s_add_u32 s78, s84, 1245184
s_mul_i32 s79, s72, 7168
s_add_u32 s79, s79, 1261568
v_lshlrev_b32 v17, 7, v1
s_mov_b32 s96, -1
s_mov_b32 s97, 0x00ffffff
s_cmp_eq_u32 s72, 0
s_cbranch_scc0 L183
v_and_b32 v18, 3, v1
v_lshlrev_b32 v18, 12, v18
v_lshlrev_b32 v17, 8, v1
v_add_u32 v17, v17, v18
v_add_u32 v17, 1245312, v17
s_mov_b32 s83, 0
s_mov_b64 exec, 0xff
L182:
buffer_load_dword v18, v17, s[60:63], 0 offen sc1
s_waitcnt vmcnt(0)
v_cmp_eq_u32 vcc, -1, v18
s_cbranch_vccz L183
s_add_u32 s83, s83, 1
s_cmp_gt_u32 s83, 4000
s_cbranch_scc1 L183
s_sleep 2
s_branch L182
L183:
s_mov_b64 exec, -1
s_waitcnt vmcnt(0)
s_barrier
s_mov_b32 s83, 0
L184:
buffer_load_dwordx4 v[32:35], v16, s[60:63], s76 offen sc1
buffer_load_dwordx4 v[36:39], v16, s[60:63], s77 offen sc1
buffer_load_dwordx2 v[40:41], v15, s[60:63], s78 offen sc1
s_sleep 1
L186:
s_waitcnt vmcnt(0)
v_max3_u32 v17, v32, v33, v34
v_max3_u32 v17, v17, v35, v36
v_max3_u32 v17, v17, v37, v38
v_max3_u32 v17, v17, v39, v40
v_max_u32 v17, v17, v41
v_cmp_eq_u32 vcc, -1, v17
s_cbranch_vccz L185
s_mov_b64 exec, vcc
s_add_u32 s83, s83, 1
s_cmp_gt_u32 s83, 1048576
s_cbranch_scc0 L184
L185:
s_mov_b64 exec, -1
v_pk_add_f32 v[20:21], v[32:33], v[36:37]
v_pk_add_f32 v[22:23], v[34:35], v[38:39]
v_mov_b32 v24, v20
v_mov_b32 v25, v21
v_mov_b32 v26, v22
v_mov_b32 v27, v23
v_permlane16_swap_b32 v20, v24
v_permlane16_swap_b32 v21, v25
v_permlane16_swap_b32 v22, v26
v_permlane16_swap_b32 v23, v27
v_pk_add_f32 v[20:21], v[20:21], v[24:25]
v_pk_add_f32 v[22:23], v[22:23], v[26:27]
v_mov_b32 v24, v20
v_mov_b32 v25, v21
v_mov_b32 v26, v22
v_mov_b32 v27, v23
v_permlane32_swap_b32 v20, v24
v_permlane32_swap_b32 v21, v25
v_permlane32_swap_b32 v22, v26
v_permlane32_swap_b32 v23, v27
v_pk_add_f32 v[20:21], v[20:21], v[24:25]
v_pk_add_f32 v[22:23], v[22:23], v[26:27]
v_cvt_pk_bf16_f32 v24, v20, v21
v_cvt_pk_bf16_f32 v25, v22, v23
v_lshlrev_b32 v20, 16, v24
v_and_b32 v21, 0xffff0000, v24
v_lshlrev_b32 v22, 16, v25
v_and_b32 v23, 0xffff0000, v25
v_lshlrev_b32 v24, 16, v40
v_and_b32 v25, 0xffff0000, v40
v_lshlrev_b32 v26, 16, v41
v_and_b32 v27, 0xffff0000, v41
v_pk_add_f32 v[20:21], v[20:21], v[24:25]
v_pk_add_f32 v[22:23], v[22:23], v[26:27]
v_cvt_pk_bf16_f32 v20, v20, v21
v_cvt_pk_bf16_f32 v21, v22, v23
s_mov_b64 exec, 0xffff
buffer_store_dwordx2 v[20:21], v15, s[68:71], s84 offen
s_mov_b64 exec, -1
s_cmp_eq_u32 s2, 240
s_cbranch_scc0 L187
s_cmp_eq_u32 s72, 0
s_cbranch_scc0 L187
v_mov_b32 v20, 0
v_mov_b32 v21, s98
s_mov_b32 s77, 2162688
s_mov_b64 exec, 1
buffer_store_dword v21, v20, s[60:63], s77 offen sc0 sc1
s_mov_b64 exec, -1
L187:
L_end:
s_endpgm
.section .rodata,"a"
.p2align 6
.amdhsa_kernel sequential_preLN__mha_block_cached__geglu_ffn__decode_kernel
  .amdhsa_next_free_vgpr 256
  .amdhsa_next_free_sgpr 102
  .amdhsa_accum_offset 256
  .amdhsa_group_segment_fixed_size 0
  .amdhsa_kernarg_size 96
  .amdhsa_user_sgpr_count 2
  .amdhsa_user_sgpr_kernarg_segment_ptr 1
  .amdhsa_system_sgpr_workgroup_id_x 1
.end_amdhsa_kernel
```
